```python
import torch

def _softmax(x, axis=-1):
    return torch.softmax(x, dim=axis)
def _gelu(x):
    return torch.nn.functional.gelu(x, approximate="tanh")
def _silu(x):
    return torch.nn.functional.silu(x)
def _sigmoid(x):
    return torch.sigmoid(x)
def _layernorm(x, axis=-1, eps=1e-5):
    m = x.mean(dim=axis, keepdim=True)
    v = x.var(dim=axis, keepdim=True, unbiased=False)
    return (x - m) / torch.sqrt(v + eps)
def _scatter_add(tgt, idx, src, axis=0):
    return tgt.clone().index_add_(axis, idx, src)
def _segment_sum(src, seg, n):
    out = torch.zeros((n,) + src.shape[1:], dtype=src.dtype)
    return out.index_add_(0, seg, src)
def _pad(x, pw):
    flat = tuple(v for pair in reversed(pw) for v in pair)
    return torch.nn.functional.pad(x, flat)

kernel_name = 'concat_heads__mha_block_cached__gqa_block_cached__near_ridge'

def setup_inputs():

    _w = (lambda a: (lambda t: t.to(torch.bfloat16) if t.is_floating_point() else t)(torch.as_tensor(a)))
    def _A_setup():
        B, Sq, D = 8, 128, 512
        H, Sk, Dh = 32, 512, 128
        return {
            "x": _w((lambda *s: torch.randn(*s, dtype=torch.bfloat16) * 0.8)(B, Sq, D)),
            "k_cache": _w((lambda *s: torch.randn(*s, dtype=torch.bfloat16) * 0.8)(B, H, Sk, Dh)),
            "v_cache": _w((lambda *s: torch.randn(*s, dtype=torch.bfloat16) * 0.05)(B, H, Sk, Dh)),
            "wq": _w((lambda *s: torch.randn(*s, dtype=torch.bfloat16) * 0.8)(D, H * Dh) * (D ** -0.5)),
            "wo": _w((lambda *s: torch.randn(*s, dtype=torch.bfloat16) * 0.05)(H * Dh, D) * ((H * Dh) ** -0.5)),
        }
    _A_in = _A_setup()

    def _B_setup():
        B, Sq, D = 8, 128, 512
        Hq, Hkv, Sk, Dh = 32, 32, 512, 128
        assert Hq % Hkv == 0, (Hq, Hkv)
        return {
            "x": _w((lambda *s: torch.randn(*s, dtype=torch.bfloat16) * 0.8)(B, Sq, D)),
            "k_cache": _w((lambda *s: torch.randn(*s, dtype=torch.bfloat16) * 0.8)(B, Hkv, Sk, Dh)),
            "v_cache": _w((lambda *s: torch.randn(*s, dtype=torch.bfloat16) * 0.05)(B, Hkv, Sk, Dh)),
            "wq": _w((lambda *s: torch.randn(*s, dtype=torch.bfloat16) * 0.8)(D, Hq * Dh) * (D ** -0.5)),
            "wo": _w((lambda *s: torch.randn(*s, dtype=torch.bfloat16) * 0.05)(Hq * Dh, D) * ((Hq * Dh) ** -0.5)),
        }
    _B_in = _B_setup()

    return {
        "A_x": _A_in["x"],
        "A_k_cache": _A_in["k_cache"],
        "A_v_cache": _A_in["v_cache"],
        "A_wq": _A_in["wq"],
        "A_wo": _A_in["wo"],
        "B_x": _B_in["x"],
        "B_k_cache": _B_in["k_cache"],
        "B_v_cache": _B_in["v_cache"],
        "B_wq": _B_in["wq"],
        "B_wo": _B_in["wo"],
    }

def reference(A_x, A_k_cache, A_v_cache, A_wq, A_wo, B_x, B_k_cache, B_v_cache, B_wq, B_wo):
    def _A_ref(x, k_cache, v_cache, wq, wo):
        B, Sq, D = x.shape
        H, Dh = 32, 128
        q = (lambda x, *d: x.permute(*d))((x @ wq).reshape(B, Sq, H, Dh), 0, 2, 1, 3)
        scores = torch.einsum("bhqd,bhkd->bhqk", q, k_cache) * (Dh ** -0.5)
        p = _softmax(scores, axis=-1)
        o = torch.einsum("bhqk,bhkd->bhqd", p, v_cache)
        return (lambda x, *d: x.permute(*d))(o, 0, 2, 1, 3).reshape(B, Sq, H * Dh) @ wo

    def _B_ref(x, k_cache, v_cache, wq, wo):
        B, Sq, D = x.shape
        Hq, Dh = 32, 128
        Hkv = k_cache.shape[1]
        rep = Hq // Hkv
        q = (lambda x, *d: x.permute(*d))((x @ wq).reshape(B, Sq, Hq, Dh), 0, 2, 1, 3)
        k = (lambda x, n, axis: torch.repeat_interleave(x, n, dim=axis))(k_cache, rep, axis=1)
        v = (lambda x, n, axis: torch.repeat_interleave(x, n, dim=axis))(v_cache, rep, axis=1)
        scores = torch.einsum("bhqd,bhkd->bhqk", q, k) * (Dh ** -0.5)
        p = _softmax(scores, axis=-1)
        o = torch.einsum("bhqk,bhkd->bhqd", p, v)
        return (lambda x, *d: x.permute(*d))(o, 0, 2, 1, 3).reshape(B, Sq, Hq * Dh) @ wo

    a = _A_ref(A_x, A_k_cache, A_v_cache, A_wq, A_wo)
    b = _B_ref(B_x, B_k_cache, B_v_cache, B_wq, B_wo)
    return torch.concatenate([a, b], axis=-1)
```

```asm
; @launch grid=(256,1,1) block=(512,1,1) lds=163840
.amdgcn_target "amdgcn-amd-amdhsa--gfx950"
.text
.globl concat_heads__mha_block_cached__gqa_block_cached__near_ridge_kernel
.p2align 8
.type concat_heads__mha_block_cached__gqa_block_cached__near_ridge_kernel,@function
concat_heads__mha_block_cached__gqa_block_cached__near_ridge_kernel:
s_cmp_ge_u32 s2, 256
s_cbranch_scc1 L1_end
s_load_dwordx16 s[4:19], s[0:1], 0
s_load_dwordx8 s[20:27], s[0:1], 64
s_load_dwordx2 s[28:29], s[0:1], 96
v_lshrrev_b32 v13, 6, v0
v_and_b32 v1, 63, v0
v_readfirstlane_b32 s52, v13
s_and_b32 s57, s2, 1
s_lshr_b32 s59, s2, 1
s_and_b32 s59, s59, 3
s_lshl_b32 s59, s59, 3
s_lshr_b32 s60, s2, 3
s_and_b32 s60, s60, 7
s_add_u32 s55, s59, s60
s_lshr_b32 s53, s52, 2
s_and_b32 s54, s52, 3
s_lshr_b32 s56, s2, 6
s_lshl_b32 s56, s56, 1
s_lshr_b32 s59, s2, 6
s_add_u32 s59, s59, s60
s_and_b32 s59, s59, 3
s_mov_b32 s67, 0x76532140
s_cmp_eq_u32 s59, 1
s_cmov_b32 s67, 0x76403521
s_cmp_eq_u32 s59, 2
s_cmov_b32 s67, 0x75416032
s_cmp_eq_u32 s59, 3
s_cmov_b32 s67, 0x65472103
s_add_u32 s56, s56, s53
v_lshrrev_b32 v13, 4, v1
v_and_b32 v14, 15, v1
v_lshlrev_b32 v15, 2, v13
v_xor_b32 v14, v14, v15
v_lshlrev_b32 v15, 4, v14
v_lshl_add_u32 v4, v13, 13, v15
v_lshl_add_u32 v3, v13, 8, v15
v_xor_b32 v14, s54, v14
v_lshlrev_b32 v15, 4, v14
v_lshl_add_u32 v2, v13, 8, v15
v_bfe_u32 v13, v1, 2, 3
v_lshlrev_b32 v13, 12, v13
v_lshrrev_b32 v14, 5, v1
v_lshlrev_b32 v14, 6, v14
v_and_b32 v15, 3, v1
v_lshlrev_b32 v15, 4, v15
v_add3_u32 v5, v13, v14, v15
s_lshl_b32 s76, s56, 2
s_add_u32 s76, s76, s54
s_lshl_b32 s76, s76, 15
s_lshl_b32 s77, s52, 16
s_lshl_b32 s59, s55, 8
s_add_u32 s77, s77, s59
s_lshl_b32 s58, s56, 5
s_add_u32 s58, s58, s55
s_lshl_b32 s58, s58, 17
s_lshl_b32 s59, s54, 12
s_add_u32 s58, s58, s59
s_lshl_b32 s65, s52, 12
s_lshl_b32 s66, s52, 11
s_waitcnt lgkmcnt(0)
s_cmp_eq_u32 s57, 1
s_cselect_b32 s44, s20, s10
s_cselect_b32 s45, s21, s11
s_mov_b32 s46, 0x400000
s_mov_b32 s47, 0x00020000
s_cselect_b32 s32, s14, s4
s_cselect_b32 s33, s15, s5
s_mov_b32 s34, 0x100000
s_mov_b32 s35, 0x00020000
s_cselect_b32 s80, s22, s12
s_cselect_b32 s81, s23, s13
s_mov_b32 s82, 0x400000
s_mov_b32 s83, 0x00020000
s_cselect_b32 s36, s16, s6
s_cselect_b32 s37, s17, s7
s_mov_b32 s38, 0x2000000
s_mov_b32 s39, 0x00020000
s_cselect_b32 s40, s18, s8
s_cselect_b32 s41, s19, s9
s_mov_b32 s42, 0x2000000
s_mov_b32 s43, 0x00020000
s_mov_b32 s48, s28
s_mov_b32 s49, s29
s_mov_b32 s50, 0x1100000
s_mov_b32 s51, 0x00020000
s_bfe_u32 s60, s67, 0x40000
s_lshl_b32 s60, s60, 19
s_add_u32 s60, s60, s77
s_add_u32 m0, s66, 0
s_add_u32 s60, s60, 0
buffer_load_dwordx4 v4, s[44:47], s60 offen  lds
s_add_u32 m0, s66, 1024
s_add_u32 s60, s60, 32768
buffer_load_dwordx4 v4, s[44:47], s60 offen  lds
s_bfe_u32 s60, s67, 0x40000
s_lshl_b32 s60, s60, 7
s_add_u32 s60, s60, s76
buffer_load_dwordx4 v[128:131], v5, s[32:35], s60 offen offset:0
buffer_load_dwordx4 v[132:135], v5, s[32:35], s60 offen offset:1024
buffer_load_dwordx4 v[136:139], v5, s[32:35], s60 offen offset:2048
buffer_load_dwordx4 v[140:143], v5, s[32:35], s60 offen offset:3072
s_bfe_u32 s60, s67, 0x40004
s_lshl_b32 s60, s60, 7
s_add_u32 s60, s60, s76
buffer_load_dwordx4 v[144:147], v5, s[32:35], s60 offen offset:0
buffer_load_dwordx4 v[148:151], v5, s[32:35], s60 offen offset:1024
buffer_load_dwordx4 v[152:155], v5, s[32:35], s60 offen offset:2048
buffer_load_dwordx4 v[156:159], v5, s[32:35], s60 offen offset:3072
s_bfe_u32 s60, s67, 0x40004
s_lshl_b32 s60, s60, 19
s_add_u32 s60, s60, s77
s_add_u32 m0, s66, 16384
s_add_u32 s60, s60, 0
buffer_load_dwordx4 v4, s[44:47], s60 offen  lds
s_add_u32 m0, s66, 17408
s_add_u32 s60, s60, 32768
buffer_load_dwordx4 v4, s[44:47], s60 offen  lds
v_bfe_u32 v13, v1, 2, 2
v_lshrrev_b32 v14, 5, v1
v_bfe_u32 v15, v1, 4, 1
v_mul_u32_u24 v16, 320, v13
v_lshl_add_u32 v16, v15, 5, v16
v_lshl_add_u32 v20, v14, 13, v16
v_and_b32 v15, 1, v1
v_lshl_add_u32 v20, v15, 4, v20
v_bfe_u32 v15, v1, 1, 1
v_lshl_add_u32 v20, v15, 3, v20
v_xor_b32 v21, 64, v20
v_xor_b32 v22, 128, v20
v_xor_b32 v23, 192, v20
v_lshl_add_u32 v7, v14, 12, v16
v_and_b32 v15, 3, v1
v_lshl_add_u32 v7, v15, 3, v7
s_lshl_b32 s59, s53, 14
v_add_u32 v7, s59, v7
v_lshlrev_b32 v6, 12, v13
v_bfe_u32 v16, v1, 4, 1
v_lshl_add_u32 v6, v16, 10, v6
v_lshl_add_u32 v6, v15, 8, v6
v_lshl_add_u32 v16, v15, 2, v13
v_xor_b32 v16, v16, v14
v_lshl_add_u32 v6, v16, 4, v6
v_add_u32 v6, s59, v6
s_mov_b32 s68, 0x55555555
s_mov_b32 s69, 0x55555555
s_mov_b32 s70, 0xaaaaaaaa
s_mov_b32 s71, 0xaaaaaaaa
s_mov_b32 s72, 0x33333333
s_mov_b32 s73, 0x33333333
s_mov_b32 s74, 0xcccccccc
s_mov_b32 s75, 0xcccccccc
s_mov_b32 s64, 0x3e0293ee
s_waitcnt vmcnt(6)
s_barrier
ds_read_b64_tr_b16 v[208:209], v20 offset:0
ds_read_b64_tr_b16 v[210:211], v20 offset:1024
ds_read_b64_tr_b16 v[212:213], v21 offset:0
ds_read_b64_tr_b16 v[214:215], v21 offset:1024
ds_read_b64_tr_b16 v[216:217], v22 offset:0
ds_read_b64_tr_b16 v[218:219], v22 offset:1024
ds_read_b64_tr_b16 v[220:221], v23 offset:0
ds_read_b64_tr_b16 v[222:223], v23 offset:1024
ds_read_b64_tr_b16 v[224:225], v20 offset:2048
ds_read_b64_tr_b16 v[226:227], v20 offset:3072
ds_read_b64_tr_b16 v[228:229], v21 offset:2048
ds_read_b64_tr_b16 v[230:231], v21 offset:3072
s_mov_b64 vcc, s[68:69]
v_cndmask_b32_dpp v192, v132, v128, vcc quad_perm:[1,0,3,2] row_mask:0xf bank_mask:0xf
s_bfe_u32 s60, s67, 0x40008
s_lshl_b32 s60, s60, 19
s_add_u32 s60, s60, s77
s_add_u32 m0, s66, 32768
s_add_u32 s60, s60, 0
buffer_load_dwordx4 v4, s[44:47], s60 offen  lds
v_cndmask_b32_dpp v193, v133, v129, vcc quad_perm:[1,0,3,2] row_mask:0xf bank_mask:0xf
v_cndmask_b32_dpp v194, v134, v130, vcc quad_perm:[1,0,3,2] row_mask:0xf bank_mask:0xf
v_cndmask_b32_dpp v195, v135, v131, vcc quad_perm:[1,0,3,2] row_mask:0xf bank_mask:0xf
v_cndmask_b32_dpp v200, v140, v136, vcc quad_perm:[1,0,3,2] row_mask:0xf bank_mask:0xf
s_add_u32 m0, s66, 33792
s_add_u32 s60, s60, 32768
buffer_load_dwordx4 v4, s[44:47], s60 offen  lds
v_cndmask_b32_dpp v201, v141, v137, vcc quad_perm:[1,0,3,2] row_mask:0xf bank_mask:0xf
v_cndmask_b32_dpp v202, v142, v138, vcc quad_perm:[1,0,3,2] row_mask:0xf bank_mask:0xf
v_cndmask_b32_dpp v203, v143, v139, vcc quad_perm:[1,0,3,2] row_mask:0xf bank_mask:0xf
s_mov_b64 vcc, s[70:71]
v_cndmask_b32_dpp v196, v128, v132, vcc quad_perm:[1,0,3,2] row_mask:0xf bank_mask:0xf
s_bfe_u32 s60, s67, 0x40008
s_lshl_b32 s60, s60, 7
s_add_u32 s60, s60, s76
buffer_load_dwordx4 v[160:163], v5, s[32:35], s60 offen offset:0
v_cndmask_b32_dpp v197, v129, v133, vcc quad_perm:[1,0,3,2] row_mask:0xf bank_mask:0xf
v_cndmask_b32_dpp v198, v130, v134, vcc quad_perm:[1,0,3,2] row_mask:0xf bank_mask:0xf
v_cndmask_b32_dpp v199, v131, v135, vcc quad_perm:[1,0,3,2] row_mask:0xf bank_mask:0xf
v_cndmask_b32_dpp v204, v136, v140, vcc quad_perm:[1,0,3,2] row_mask:0xf bank_mask:0xf
buffer_load_dwordx4 v[164:167], v5, s[32:35], s60 offen offset:1024
v_cndmask_b32_dpp v205, v137, v141, vcc quad_perm:[1,0,3,2] row_mask:0xf bank_mask:0xf
v_cndmask_b32_dpp v206, v138, v142, vcc quad_perm:[1,0,3,2] row_mask:0xf bank_mask:0xf
v_cndmask_b32_dpp v207, v139, v143, vcc quad_perm:[1,0,3,2] row_mask:0xf bank_mask:0xf
s_mov_b64 vcc, s[72:73]
v_cndmask_b32_dpp v128, v200, v192, vcc quad_perm:[2,3,0,1] row_mask:0xf bank_mask:0xf
buffer_load_dwordx4 v[168:171], v5, s[32:35], s60 offen offset:2048
v_cndmask_b32_dpp v129, v201, v193, vcc quad_perm:[2,3,0,1] row_mask:0xf bank_mask:0xf
v_cndmask_b32_dpp v130, v202, v194, vcc quad_perm:[2,3,0,1] row_mask:0xf bank_mask:0xf
v_cndmask_b32_dpp v131, v203, v195, vcc quad_perm:[2,3,0,1] row_mask:0xf bank_mask:0xf
v_cndmask_b32_dpp v132, v204, v196, vcc quad_perm:[2,3,0,1] row_mask:0xf bank_mask:0xf
buffer_load_dwordx4 v[172:175], v5, s[32:35], s60 offen offset:3072
v_cndmask_b32_dpp v133, v205, v197, vcc quad_perm:[2,3,0,1] row_mask:0xf bank_mask:0xf
v_cndmask_b32_dpp v134, v206, v198, vcc quad_perm:[2,3,0,1] row_mask:0xf bank_mask:0xf
v_cndmask_b32_dpp v135, v207, v199, vcc quad_perm:[2,3,0,1] row_mask:0xf bank_mask:0xf
s_mov_b64 vcc, s[74:75]
v_cndmask_b32_dpp v136, v192, v200, vcc quad_perm:[2,3,0,1] row_mask:0xf bank_mask:0xf
v_cndmask_b32_dpp v137, v193, v201, vcc quad_perm:[2,3,0,1] row_mask:0xf bank_mask:0xf
v_cndmask_b32_dpp v138, v194, v202, vcc quad_perm:[2,3,0,1] row_mask:0xf bank_mask:0xf
v_cndmask_b32_dpp v139, v195, v203, vcc quad_perm:[2,3,0,1] row_mask:0xf bank_mask:0xf
v_cndmask_b32_dpp v140, v196, v204, vcc quad_perm:[2,3,0,1] row_mask:0xf bank_mask:0xf
v_cndmask_b32_dpp v141, v197, v205, vcc quad_perm:[2,3,0,1] row_mask:0xf bank_mask:0xf
v_cndmask_b32_dpp v142, v198, v206, vcc quad_perm:[2,3,0,1] row_mask:0xf bank_mask:0xf
v_cndmask_b32_dpp v143, v199, v207, vcc quad_perm:[2,3,0,1] row_mask:0xf bank_mask:0xf
s_nop 1
s_waitcnt vmcnt(8)
s_waitcnt lgkmcnt(10)
v_mfma_f32_32x32x16_bf16 v[64:79], v[208:211], v[128:131], 0
ds_read_b64_tr_b16 v[232:233], v22 offset:2048
ds_read_b64_tr_b16 v[234:235], v22 offset:3072
s_bfe_u32 s60, s67, 0x4000c
s_lshl_b32 s60, s60, 7
s_add_u32 s60, s60, s76
buffer_load_dwordx4 v[176:179], v5, s[32:35], s60 offen offset:0
s_mov_b64 vcc, s[68:69]
v_cndmask_b32_dpp v192, v148, v144, vcc quad_perm:[1,0,3,2] row_mask:0xf bank_mask:0xf
v_cndmask_b32_dpp v193, v149, v145, vcc quad_perm:[1,0,3,2] row_mask:0xf bank_mask:0xf
v_cndmask_b32_dpp v194, v150, v146, vcc quad_perm:[1,0,3,2] row_mask:0xf bank_mask:0xf
s_waitcnt lgkmcnt(10)
v_mfma_f32_32x32x16_bf16 v[80:95], v[212:215], v[128:131], 0
ds_read_b64_tr_b16 v[236:237], v23 offset:2048
ds_read_b64_tr_b16 v[238:239], v23 offset:3072
v_cndmask_b32_dpp v195, v151, v147, vcc quad_perm:[1,0,3,2] row_mask:0xf bank_mask:0xf
v_cndmask_b32_dpp v200, v156, v152, vcc quad_perm:[1,0,3,2] row_mask:0xf bank_mask:0xf
s_waitcnt lgkmcnt(10)
v_mfma_f32_32x32x16_bf16 v[96:111], v[216:219], v[128:131], 0
ds_read_b64_tr_b16 v[208:209], v20 offset:4096
ds_read_b64_tr_b16 v[210:211], v20 offset:5120
buffer_load_dwordx4 v[180:183], v5, s[32:35], s60 offen offset:1024
v_cndmask_b32_dpp v201, v157, v153, vcc quad_perm:[1,0,3,2] row_mask:0xf bank_mask:0xf
v_cndmask_b32_dpp v202, v158, v154, vcc quad_perm:[1,0,3,2] row_mask:0xf bank_mask:0xf
s_waitcnt lgkmcnt(10)
v_mfma_f32_32x32x16_bf16 v[112:127], v[220:223], v[128:131], 0
ds_read_b64_tr_b16 v[212:213], v21 offset:4096
ds_read_b64_tr_b16 v[214:215], v21 offset:5120
v_cndmask_b32_dpp v203, v159, v155, vcc quad_perm:[1,0,3,2] row_mask:0xf bank_mask:0xf
s_mov_b64 vcc, s[70:71]
v_cndmask_b32_dpp v196, v144, v148, vcc quad_perm:[1,0,3,2] row_mask:0xf bank_mask:0xf
s_waitcnt lgkmcnt(10)
v_mfma_f32_32x32x16_bf16 v[64:79], v[224:227], v[132:135], v[64:79]
ds_read_b64_tr_b16 v[216:217], v22 offset:4096
ds_read_b64_tr_b16 v[218:219], v22 offset:5120
buffer_load_dwordx4 v[184:187], v5, s[32:35], s60 offen offset:2048
v_cndmask_b32_dpp v197, v145, v149, vcc quad_perm:[1,0,3,2] row_mask:0xf bank_mask:0xf
v_cndmask_b32_dpp v198, v146, v150, vcc quad_perm:[1,0,3,2] row_mask:0xf bank_mask:0xf
s_waitcnt lgkmcnt(10)
v_mfma_f32_32x32x16_bf16 v[80:95], v[228:231], v[132:135], v[80:95]
ds_read_b64_tr_b16 v[220:221], v23 offset:4096
ds_read_b64_tr_b16 v[222:223], v23 offset:5120
v_cndmask_b32_dpp v199, v147, v151, vcc quad_perm:[1,0,3,2] row_mask:0xf bank_mask:0xf
v_cndmask_b32_dpp v204, v152, v156, vcc quad_perm:[1,0,3,2] row_mask:0xf bank_mask:0xf
s_waitcnt lgkmcnt(10)
v_mfma_f32_32x32x16_bf16 v[96:111], v[232:235], v[132:135], v[96:111]
ds_read_b64_tr_b16 v[224:225], v20 offset:6144
ds_read_b64_tr_b16 v[226:227], v20 offset:7168
buffer_load_dwordx4 v[188:191], v5, s[32:35], s60 offen offset:3072
v_cndmask_b32_dpp v205, v153, v157, vcc quad_perm:[1,0,3,2] row_mask:0xf bank_mask:0xf
v_cndmask_b32_dpp v206, v154, v158, vcc quad_perm:[1,0,3,2] row_mask:0xf bank_mask:0xf
s_waitcnt lgkmcnt(10)
v_mfma_f32_32x32x16_bf16 v[112:127], v[236:239], v[132:135], v[112:127]
ds_read_b64_tr_b16 v[228:229], v21 offset:6144
ds_read_b64_tr_b16 v[230:231], v21 offset:7168
v_cndmask_b32_dpp v207, v155, v159, vcc quad_perm:[1,0,3,2] row_mask:0xf bank_mask:0xf
s_mov_b64 vcc, s[72:73]
v_cndmask_b32_dpp v144, v200, v192, vcc quad_perm:[2,3,0,1] row_mask:0xf bank_mask:0xf
v_cndmask_b32_dpp v145, v201, v193, vcc quad_perm:[2,3,0,1] row_mask:0xf bank_mask:0xf
s_waitcnt lgkmcnt(10)
v_mfma_f32_32x32x16_bf16 v[64:79], v[208:211], v[136:139], v[64:79]
ds_read_b64_tr_b16 v[232:233], v22 offset:6144
ds_read_b64_tr_b16 v[234:235], v22 offset:7168
v_cndmask_b32_dpp v146, v202, v194, vcc quad_perm:[2,3,0,1] row_mask:0xf bank_mask:0xf
v_cndmask_b32_dpp v147, v203, v195, vcc quad_perm:[2,3,0,1] row_mask:0xf bank_mask:0xf
s_waitcnt lgkmcnt(10)
v_mfma_f32_32x32x16_bf16 v[80:95], v[212:215], v[136:139], v[80:95]
ds_read_b64_tr_b16 v[236:237], v23 offset:6144
ds_read_b64_tr_b16 v[238:239], v23 offset:7168
s_waitcnt vmcnt(10)
s_barrier
s_bfe_u32 s60, s67, 0x4000c
s_lshl_b32 s60, s60, 19
s_add_u32 s60, s60, s77
s_add_u32 m0, s66, 49152
s_add_u32 s60, s60, 0
buffer_load_dwordx4 v4, s[44:47], s60 offen  lds
v_cndmask_b32_dpp v148, v204, v196, vcc quad_perm:[2,3,0,1] row_mask:0xf bank_mask:0xf
v_cndmask_b32_dpp v149, v205, v197, vcc quad_perm:[2,3,0,1] row_mask:0xf bank_mask:0xf
s_waitcnt lgkmcnt(10)
v_mfma_f32_32x32x16_bf16 v[96:111], v[216:219], v[136:139], v[96:111]
ds_read_b64_tr_b16 v[208:209], v20 offset:16384
ds_read_b64_tr_b16 v[210:211], v20 offset:17408
s_add_u32 m0, s66, 50176
s_add_u32 s60, s60, 32768
buffer_load_dwordx4 v4, s[44:47], s60 offen  lds
v_cndmask_b32_dpp v150, v206, v198, vcc quad_perm:[2,3,0,1] row_mask:0xf bank_mask:0xf
v_cndmask_b32_dpp v151, v207, v199, vcc quad_perm:[2,3,0,1] row_mask:0xf bank_mask:0xf
s_waitcnt lgkmcnt(10)
v_mfma_f32_32x32x16_bf16 v[112:127], v[220:223], v[136:139], v[112:127]
ds_read_b64_tr_b16 v[212:213], v21 offset:16384
ds_read_b64_tr_b16 v[214:215], v21 offset:17408
s_mov_b64 vcc, s[74:75]
v_cndmask_b32_dpp v152, v192, v200, vcc quad_perm:[2,3,0,1] row_mask:0xf bank_mask:0xf
v_cndmask_b32_dpp v153, v193, v201, vcc quad_perm:[2,3,0,1] row_mask:0xf bank_mask:0xf
s_waitcnt lgkmcnt(10)
v_mfma_f32_32x32x16_bf16 v[64:79], v[224:227], v[140:143], v[64:79]
ds_read_b64_tr_b16 v[216:217], v22 offset:16384
ds_read_b64_tr_b16 v[218:219], v22 offset:17408
s_add_u32 m0, s65, 65536
s_add_u32 s59, s58, 0
buffer_load_dwordx4 v2, s[36:39], s59 offen offset:0 nt lds
v_cndmask_b32_dpp v154, v194, v202, vcc quad_perm:[2,3,0,1] row_mask:0xf bank_mask:0xf
v_cndmask_b32_dpp v155, v195, v203, vcc quad_perm:[2,3,0,1] row_mask:0xf bank_mask:0xf
s_waitcnt lgkmcnt(10)
v_mfma_f32_32x32x16_bf16 v[80:95], v[228:231], v[140:143], v[80:95]
ds_read_b64_tr_b16 v[220:221], v23 offset:16384
ds_read_b64_tr_b16 v[222:223], v23 offset:17408
v_cndmask_b32_dpp v156, v196, v204, vcc quad_perm:[2,3,0,1] row_mask:0xf bank_mask:0xf
v_cndmask_b32_dpp v157, v197, v205, vcc quad_perm:[2,3,0,1] row_mask:0xf bank_mask:0xf
s_waitcnt lgkmcnt(10)
v_mfma_f32_32x32x16_bf16 v[96:111], v[232:235], v[140:143], v[96:111]
ds_read_b64_tr_b16 v[224:225], v20 offset:18432
ds_read_b64_tr_b16 v[226:227], v20 offset:19456
s_add_u32 m0, s65, 65536
s_add_u32 s59, s58, 0
buffer_load_dwordx4 v2, s[36:39], s59 offen offset:1024 nt lds
v_cndmask_b32_dpp v158, v198, v206, vcc quad_perm:[2,3,0,1] row_mask:0xf bank_mask:0xf
v_cndmask_b32_dpp v159, v199, v207, vcc quad_perm:[2,3,0,1] row_mask:0xf bank_mask:0xf
s_waitcnt lgkmcnt(10)
v_mfma_f32_32x32x16_bf16 v[112:127], v[236:239], v[140:143], v[112:127]
ds_read_b64_tr_b16 v[228:229], v21 offset:18432
ds_read_b64_tr_b16 v[230:231], v21 offset:19456
s_waitcnt vmcnt(8)
s_waitcnt lgkmcnt(10)
v_mfma_f32_32x32x16_bf16 v[64:79], v[208:211], v[144:147], v[64:79]
ds_read_b64_tr_b16 v[232:233], v22 offset:18432
ds_read_b64_tr_b16 v[234:235], v22 offset:19456
s_bfe_u32 s60, s67, 0x40010
s_lshl_b32 s60, s60, 7
s_add_u32 s60, s60, s76
buffer_load_dwordx4 v[128:131], v5, s[32:35], s60 offen offset:0
s_mov_b64 vcc, s[68:69]
v_cndmask_b32_dpp v192, v164, v160, vcc quad_perm:[1,0,3,2] row_mask:0xf bank_mask:0xf
v_cndmask_b32_dpp v193, v165, v161, vcc quad_perm:[1,0,3,2] row_mask:0xf bank_mask:0xf
v_cndmask_b32_dpp v194, v166, v162, vcc quad_perm:[1,0,3,2] row_mask:0xf bank_mask:0xf
s_waitcnt lgkmcnt(10)
v_mfma_f32_32x32x16_bf16 v[80:95], v[212:215], v[144:147], v[80:95]
ds_read_b64_tr_b16 v[236:237], v23 offset:18432
ds_read_b64_tr_b16 v[238:239], v23 offset:19456
v_cndmask_b32_dpp v195, v167, v163, vcc quad_perm:[1,0,3,2] row_mask:0xf bank_mask:0xf
v_cndmask_b32_dpp v200, v172, v168, vcc quad_perm:[1,0,3,2] row_mask:0xf bank_mask:0xf
s_waitcnt lgkmcnt(10)
v_mfma_f32_32x32x16_bf16 v[96:111], v[216:219], v[144:147], v[96:111]
ds_read_b64_tr_b16 v[208:209], v20 offset:20480
ds_read_b64_tr_b16 v[210:211], v20 offset:21504
buffer_load_dwordx4 v[132:135], v5, s[32:35], s60 offen offset:1024
v_cndmask_b32_dpp v201, v173, v169, vcc quad_perm:[1,0,3,2] row_mask:0xf bank_mask:0xf
v_cndmask_b32_dpp v202, v174, v170, vcc quad_perm:[1,0,3,2] row_mask:0xf bank_mask:0xf
s_waitcnt lgkmcnt(10)
v_mfma_f32_32x32x16_bf16 v[112:127], v[220:223], v[144:147], v[112:127]
ds_read_b64_tr_b16 v[212:213], v21 offset:20480
ds_read_b64_tr_b16 v[214:215], v21 offset:21504
v_cndmask_b32_dpp v203, v175, v171, vcc quad_perm:[1,0,3,2] row_mask:0xf bank_mask:0xf
s_mov_b64 vcc, s[70:71]
v_cndmask_b32_dpp v196, v160, v164, vcc quad_perm:[1,0,3,2] row_mask:0xf bank_mask:0xf
s_waitcnt lgkmcnt(10)
v_mfma_f32_32x32x16_bf16 v[64:79], v[224:227], v[148:151], v[64:79]
ds_read_b64_tr_b16 v[216:217], v22 offset:20480
ds_read_b64_tr_b16 v[218:219], v22 offset:21504
buffer_load_dwordx4 v[136:139], v5, s[32:35], s60 offen offset:2048
v_cndmask_b32_dpp v197, v161, v165, vcc quad_perm:[1,0,3,2] row_mask:0xf bank_mask:0xf
v_cndmask_b32_dpp v198, v162, v166, vcc quad_perm:[1,0,3,2] row_mask:0xf bank_mask:0xf
s_waitcnt lgkmcnt(10)
v_mfma_f32_32x32x16_bf16 v[80:95], v[228:231], v[148:151], v[80:95]
ds_read_b64_tr_b16 v[220:221], v23 offset:20480
ds_read_b64_tr_b16 v[222:223], v23 offset:21504
v_cndmask_b32_dpp v199, v163, v167, vcc quad_perm:[1,0,3,2] row_mask:0xf bank_mask:0xf
v_cndmask_b32_dpp v204, v168, v172, vcc quad_perm:[1,0,3,2] row_mask:0xf bank_mask:0xf
s_waitcnt lgkmcnt(10)
v_mfma_f32_32x32x16_bf16 v[96:111], v[232:235], v[148:151], v[96:111]
ds_read_b64_tr_b16 v[224:225], v20 offset:22528
ds_read_b64_tr_b16 v[226:227], v20 offset:23552
buffer_load_dwordx4 v[140:143], v5, s[32:35], s60 offen offset:3072
v_cndmask_b32_dpp v205, v169, v173, vcc quad_perm:[1,0,3,2] row_mask:0xf bank_mask:0xf
v_cndmask_b32_dpp v206, v170, v174, vcc quad_perm:[1,0,3,2] row_mask:0xf bank_mask:0xf
s_waitcnt lgkmcnt(10)
v_mfma_f32_32x32x16_bf16 v[112:127], v[236:239], v[148:151], v[112:127]
ds_read_b64_tr_b16 v[228:229], v21 offset:22528
ds_read_b64_tr_b16 v[230:231], v21 offset:23552
v_cndmask_b32_dpp v207, v171, v175, vcc quad_perm:[1,0,3,2] row_mask:0xf bank_mask:0xf
s_mov_b64 vcc, s[72:73]
v_cndmask_b32_dpp v160, v200, v192, vcc quad_perm:[2,3,0,1] row_mask:0xf bank_mask:0xf
v_cndmask_b32_dpp v161, v201, v193, vcc quad_perm:[2,3,0,1] row_mask:0xf bank_mask:0xf
s_waitcnt lgkmcnt(10)
v_mfma_f32_32x32x16_bf16 v[64:79], v[208:211], v[152:155], v[64:79]
ds_read_b64_tr_b16 v[232:233], v22 offset:22528
ds_read_b64_tr_b16 v[234:235], v22 offset:23552
v_cndmask_b32_dpp v162, v202, v194, vcc quad_perm:[2,3,0,1] row_mask:0xf bank_mask:0xf
v_cndmask_b32_dpp v163, v203, v195, vcc quad_perm:[2,3,0,1] row_mask:0xf bank_mask:0xf
s_waitcnt lgkmcnt(10)
v_mfma_f32_32x32x16_bf16 v[80:95], v[212:215], v[152:155], v[80:95]
ds_read_b64_tr_b16 v[236:237], v23 offset:22528
ds_read_b64_tr_b16 v[238:239], v23 offset:23552
s_barrier
s_bfe_u32 s60, s67, 0x40010
s_lshl_b32 s60, s60, 19
s_add_u32 s60, s60, s77
s_add_u32 m0, s66, 0
s_add_u32 s60, s60, 0
buffer_load_dwordx4 v4, s[44:47], s60 offen  lds
v_cndmask_b32_dpp v164, v204, v196, vcc quad_perm:[2,3,0,1] row_mask:0xf bank_mask:0xf
v_cndmask_b32_dpp v165, v205, v197, vcc quad_perm:[2,3,0,1] row_mask:0xf bank_mask:0xf
s_waitcnt lgkmcnt(10)
v_mfma_f32_32x32x16_bf16 v[96:111], v[216:219], v[152:155], v[96:111]
ds_read_b64_tr_b16 v[208:209], v20 offset:32768
ds_read_b64_tr_b16 v[210:211], v20 offset:33792
s_add_u32 m0, s66, 1024
s_add_u32 s60, s60, 32768
buffer_load_dwordx4 v4, s[44:47], s60 offen  lds
v_cndmask_b32_dpp v166, v206, v198, vcc quad_perm:[2,3,0,1] row_mask:0xf bank_mask:0xf
v_cndmask_b32_dpp v167, v207, v199, vcc quad_perm:[2,3,0,1] row_mask:0xf bank_mask:0xf
s_waitcnt lgkmcnt(10)
v_mfma_f32_32x32x16_bf16 v[112:127], v[220:223], v[152:155], v[112:127]
ds_read_b64_tr_b16 v[212:213], v21 offset:32768
ds_read_b64_tr_b16 v[214:215], v21 offset:33792
s_mov_b64 vcc, s[74:75]
v_cndmask_b32_dpp v168, v192, v200, vcc quad_perm:[2,3,0,1] row_mask:0xf bank_mask:0xf
v_cndmask_b32_dpp v169, v193, v201, vcc quad_perm:[2,3,0,1] row_mask:0xf bank_mask:0xf
s_waitcnt lgkmcnt(10)
v_mfma_f32_32x32x16_bf16 v[64:79], v[224:227], v[156:159], v[64:79]
ds_read_b64_tr_b16 v[216:217], v22 offset:32768
ds_read_b64_tr_b16 v[218:219], v22 offset:33792
s_add_u32 m0, s65, 65536
s_add_u32 s59, s58, 0
buffer_load_dwordx4 v2, s[36:39], s59 offen offset:2048 nt lds
v_cndmask_b32_dpp v170, v194, v202, vcc quad_perm:[2,3,0,1] row_mask:0xf bank_mask:0xf
v_cndmask_b32_dpp v171, v195, v203, vcc quad_perm:[2,3,0,1] row_mask:0xf bank_mask:0xf
s_waitcnt lgkmcnt(10)
v_mfma_f32_32x32x16_bf16 v[80:95], v[228:231], v[156:159], v[80:95]
ds_read_b64_tr_b16 v[220:221], v23 offset:32768
ds_read_b64_tr_b16 v[222:223], v23 offset:33792
v_cndmask_b32_dpp v172, v196, v204, vcc quad_perm:[2,3,0,1] row_mask:0xf bank_mask:0xf
v_cndmask_b32_dpp v173, v197, v205, vcc quad_perm:[2,3,0,1] row_mask:0xf bank_mask:0xf
s_waitcnt lgkmcnt(10)
v_mfma_f32_32x32x16_bf16 v[96:111], v[232:235], v[156:159], v[96:111]
ds_read_b64_tr_b16 v[224:225], v20 offset:34816
ds_read_b64_tr_b16 v[226:227], v20 offset:35840
s_add_u32 m0, s65, 65536
s_add_u32 s59, s58, 0
buffer_load_dwordx4 v2, s[36:39], s59 offen offset:3072 nt lds
v_cndmask_b32_dpp v174, v198, v206, vcc quad_perm:[2,3,0,1] row_mask:0xf bank_mask:0xf
v_cndmask_b32_dpp v175, v199, v207, vcc quad_perm:[2,3,0,1] row_mask:0xf bank_mask:0xf
s_waitcnt lgkmcnt(10)
v_mfma_f32_32x32x16_bf16 v[112:127], v[236:239], v[156:159], v[112:127]
ds_read_b64_tr_b16 v[228:229], v21 offset:34816
ds_read_b64_tr_b16 v[230:231], v21 offset:35840
s_waitcnt vmcnt(12)
s_waitcnt lgkmcnt(10)
v_mfma_f32_32x32x16_bf16 v[64:79], v[208:211], v[160:163], v[64:79]
ds_read_b64_tr_b16 v[232:233], v22 offset:34816
ds_read_b64_tr_b16 v[234:235], v22 offset:35840
s_bfe_u32 s60, s67, 0x40014
s_lshl_b32 s60, s60, 7
s_add_u32 s60, s60, s76
buffer_load_dwordx4 v[144:147], v5, s[32:35], s60 offen offset:0
s_mov_b64 vcc, s[68:69]
v_cndmask_b32_dpp v192, v180, v176, vcc quad_perm:[1,0,3,2] row_mask:0xf bank_mask:0xf
v_cndmask_b32_dpp v193, v181, v177, vcc quad_perm:[1,0,3,2] row_mask:0xf bank_mask:0xf
v_cndmask_b32_dpp v194, v182, v178, vcc quad_perm:[1,0,3,2] row_mask:0xf bank_mask:0xf
s_waitcnt lgkmcnt(10)
v_mfma_f32_32x32x16_bf16 v[80:95], v[212:215], v[160:163], v[80:95]
ds_read_b64_tr_b16 v[236:237], v23 offset:34816
ds_read_b64_tr_b16 v[238:239], v23 offset:35840
v_cndmask_b32_dpp v195, v183, v179, vcc quad_perm:[1,0,3,2] row_mask:0xf bank_mask:0xf
v_cndmask_b32_dpp v200, v188, v184, vcc quad_perm:[1,0,3,2] row_mask:0xf bank_mask:0xf
s_waitcnt lgkmcnt(10)
v_mfma_f32_32x32x16_bf16 v[96:111], v[216:219], v[160:163], v[96:111]
ds_read_b64_tr_b16 v[208:209], v20 offset:36864
ds_read_b64_tr_b16 v[210:211], v20 offset:37888
buffer_load_dwordx4 v[148:151], v5, s[32:35], s60 offen offset:1024
v_cndmask_b32_dpp v201, v189, v185, vcc quad_perm:[1,0,3,2] row_mask:0xf bank_mask:0xf
v_cndmask_b32_dpp v202, v190, v186, vcc quad_perm:[1,0,3,2] row_mask:0xf bank_mask:0xf
s_waitcnt lgkmcnt(10)
v_mfma_f32_32x32x16_bf16 v[112:127], v[220:223], v[160:163], v[112:127]
ds_read_b64_tr_b16 v[212:213], v21 offset:36864
ds_read_b64_tr_b16 v[214:215], v21 offset:37888
v_cndmask_b32_dpp v203, v191, v187, vcc quad_perm:[1,0,3,2] row_mask:0xf bank_mask:0xf
s_mov_b64 vcc, s[70:71]
v_cndmask_b32_dpp v196, v176, v180, vcc quad_perm:[1,0,3,2] row_mask:0xf bank_mask:0xf
s_waitcnt lgkmcnt(10)
v_mfma_f32_32x32x16_bf16 v[64:79], v[224:227], v[164:167], v[64:79]
ds_read_b64_tr_b16 v[216:217], v22 offset:36864
ds_read_b64_tr_b16 v[218:219], v22 offset:37888
buffer_load_dwordx4 v[152:155], v5, s[32:35], s60 offen offset:2048
v_cndmask_b32_dpp v197, v177, v181, vcc quad_perm:[1,0,3,2] row_mask:0xf bank_mask:0xf
v_cndmask_b32_dpp v198, v178, v182, vcc quad_perm:[1,0,3,2] row_mask:0xf bank_mask:0xf
s_waitcnt lgkmcnt(10)
v_mfma_f32_32x32x16_bf16 v[80:95], v[228:231], v[164:167], v[80:95]
ds_read_b64_tr_b16 v[220:221], v23 offset:36864
ds_read_b64_tr_b16 v[222:223], v23 offset:37888
v_cndmask_b32_dpp v199, v179, v183, vcc quad_perm:[1,0,3,2] row_mask:0xf bank_mask:0xf
v_cndmask_b32_dpp v204, v184, v188, vcc quad_perm:[1,0,3,2] row_mask:0xf bank_mask:0xf
s_waitcnt lgkmcnt(10)
v_mfma_f32_32x32x16_bf16 v[96:111], v[232:235], v[164:167], v[96:111]
ds_read_b64_tr_b16 v[224:225], v20 offset:38912
ds_read_b64_tr_b16 v[226:227], v20 offset:39936
buffer_load_dwordx4 v[156:159], v5, s[32:35], s60 offen offset:3072
v_cndmask_b32_dpp v205, v185, v189, vcc quad_perm:[1,0,3,2] row_mask:0xf bank_mask:0xf
v_cndmask_b32_dpp v206, v186, v190, vcc quad_perm:[1,0,3,2] row_mask:0xf bank_mask:0xf
s_waitcnt lgkmcnt(10)
v_mfma_f32_32x32x16_bf16 v[112:127], v[236:239], v[164:167], v[112:127]
ds_read_b64_tr_b16 v[228:229], v21 offset:38912
ds_read_b64_tr_b16 v[230:231], v21 offset:39936
v_cndmask_b32_dpp v207, v187, v191, vcc quad_perm:[1,0,3,2] row_mask:0xf bank_mask:0xf
s_mov_b64 vcc, s[72:73]
v_cndmask_b32_dpp v176, v200, v192, vcc quad_perm:[2,3,0,1] row_mask:0xf bank_mask:0xf
v_cndmask_b32_dpp v177, v201, v193, vcc quad_perm:[2,3,0,1] row_mask:0xf bank_mask:0xf
s_waitcnt lgkmcnt(10)
v_mfma_f32_32x32x16_bf16 v[64:79], v[208:211], v[168:171], v[64:79]
ds_read_b64_tr_b16 v[232:233], v22 offset:38912
ds_read_b64_tr_b16 v[234:235], v22 offset:39936
v_cndmask_b32_dpp v178, v202, v194, vcc quad_perm:[2,3,0,1] row_mask:0xf bank_mask:0xf
v_cndmask_b32_dpp v179, v203, v195, vcc quad_perm:[2,3,0,1] row_mask:0xf bank_mask:0xf
s_waitcnt lgkmcnt(10)
v_mfma_f32_32x32x16_bf16 v[80:95], v[212:215], v[168:171], v[80:95]
ds_read_b64_tr_b16 v[236:237], v23 offset:38912
ds_read_b64_tr_b16 v[238:239], v23 offset:39936
s_waitcnt vmcnt(14)
s_barrier
s_bfe_u32 s60, s67, 0x40014
s_lshl_b32 s60, s60, 19
s_add_u32 s60, s60, s77
s_add_u32 m0, s66, 16384
s_add_u32 s60, s60, 0
buffer_load_dwordx4 v4, s[44:47], s60 offen  lds
v_cndmask_b32_dpp v180, v204, v196, vcc quad_perm:[2,3,0,1] row_mask:0xf bank_mask:0xf
v_cndmask_b32_dpp v181, v205, v197, vcc quad_perm:[2,3,0,1] row_mask:0xf bank_mask:0xf
s_waitcnt lgkmcnt(10)
v_mfma_f32_32x32x16_bf16 v[96:111], v[216:219], v[168:171], v[96:111]
ds_read_b64_tr_b16 v[208:209], v20 offset:49152
ds_read_b64_tr_b16 v[210:211], v20 offset:50176
s_add_u32 m0, s66, 17408
s_add_u32 s60, s60, 32768
buffer_load_dwordx4 v4, s[44:47], s60 offen  lds
v_cndmask_b32_dpp v182, v206, v198, vcc quad_perm:[2,3,0,1] row_mask:0xf bank_mask:0xf
v_cndmask_b32_dpp v183, v207, v199, vcc quad_perm:[2,3,0,1] row_mask:0xf bank_mask:0xf
s_waitcnt lgkmcnt(10)
v_mfma_f32_32x32x16_bf16 v[112:127], v[220:223], v[168:171], v[112:127]
ds_read_b64_tr_b16 v[212:213], v21 offset:49152
ds_read_b64_tr_b16 v[214:215], v21 offset:50176
s_mov_b64 vcc, s[74:75]
v_cndmask_b32_dpp v184, v192, v200, vcc quad_perm:[2,3,0,1] row_mask:0xf bank_mask:0xf
v_cndmask_b32_dpp v185, v193, v201, vcc quad_perm:[2,3,0,1] row_mask:0xf bank_mask:0xf
s_waitcnt lgkmcnt(10)
v_mfma_f32_32x32x16_bf16 v[64:79], v[224:227], v[172:175], v[64:79]
ds_read_b64_tr_b16 v[216:217], v22 offset:49152
ds_read_b64_tr_b16 v[218:219], v22 offset:50176
s_add_u32 m0, s65, 98304
s_add_u32 s59, s58, 16384
buffer_load_dwordx4 v2, s[36:39], s59 offen offset:0 nt lds
v_cndmask_b32_dpp v186, v194, v202, vcc quad_perm:[2,3,0,1] row_mask:0xf bank_mask:0xf
v_cndmask_b32_dpp v187, v195, v203, vcc quad_perm:[2,3,0,1] row_mask:0xf bank_mask:0xf
s_waitcnt lgkmcnt(10)
v_mfma_f32_32x32x16_bf16 v[80:95], v[228:231], v[172:175], v[80:95]
ds_read_b64_tr_b16 v[220:221], v23 offset:49152
ds_read_b64_tr_b16 v[222:223], v23 offset:50176
v_cndmask_b32_dpp v188, v196, v204, vcc quad_perm:[2,3,0,1] row_mask:0xf bank_mask:0xf
v_cndmask_b32_dpp v189, v197, v205, vcc quad_perm:[2,3,0,1] row_mask:0xf bank_mask:0xf
s_waitcnt lgkmcnt(10)
v_mfma_f32_32x32x16_bf16 v[96:111], v[232:235], v[172:175], v[96:111]
ds_read_b64_tr_b16 v[224:225], v20 offset:51200
ds_read_b64_tr_b16 v[226:227], v20 offset:52224
s_add_u32 m0, s65, 98304
s_add_u32 s59, s58, 16384
buffer_load_dwordx4 v2, s[36:39], s59 offen offset:1024 nt lds
v_cndmask_b32_dpp v190, v198, v206, vcc quad_perm:[2,3,0,1] row_mask:0xf bank_mask:0xf
v_cndmask_b32_dpp v191, v199, v207, vcc quad_perm:[2,3,0,1] row_mask:0xf bank_mask:0xf
s_waitcnt lgkmcnt(10)
v_mfma_f32_32x32x16_bf16 v[112:127], v[236:239], v[172:175], v[112:127]
ds_read_b64_tr_b16 v[228:229], v21 offset:51200
ds_read_b64_tr_b16 v[230:231], v21 offset:52224
s_waitcnt vmcnt(12)
s_waitcnt lgkmcnt(10)
v_mfma_f32_32x32x16_bf16 v[64:79], v[208:211], v[176:179], v[64:79]
ds_read_b64_tr_b16 v[232:233], v22 offset:51200
ds_read_b64_tr_b16 v[234:235], v22 offset:52224
s_bfe_u32 s60, s67, 0x40018
s_lshl_b32 s60, s60, 7
s_add_u32 s60, s60, s76
buffer_load_dwordx4 v[160:163], v5, s[32:35], s60 offen offset:0
s_mov_b64 vcc, s[68:69]
v_cndmask_b32_dpp v192, v132, v128, vcc quad_perm:[1,0,3,2] row_mask:0xf bank_mask:0xf
v_cndmask_b32_dpp v193, v133, v129, vcc quad_perm:[1,0,3,2] row_mask:0xf bank_mask:0xf
v_cndmask_b32_dpp v194, v134, v130, vcc quad_perm:[1,0,3,2] row_mask:0xf bank_mask:0xf
s_waitcnt lgkmcnt(10)
v_mfma_f32_32x32x16_bf16 v[80:95], v[212:215], v[176:179], v[80:95]
ds_read_b64_tr_b16 v[236:237], v23 offset:51200
ds_read_b64_tr_b16 v[238:239], v23 offset:52224
v_cndmask_b32_dpp v195, v135, v131, vcc quad_perm:[1,0,3,2] row_mask:0xf bank_mask:0xf
v_cndmask_b32_dpp v200, v140, v136, vcc quad_perm:[1,0,3,2] row_mask:0xf bank_mask:0xf
s_waitcnt lgkmcnt(10)
v_mfma_f32_32x32x16_bf16 v[96:111], v[216:219], v[176:179], v[96:111]
ds_read_b64_tr_b16 v[208:209], v20 offset:53248
ds_read_b64_tr_b16 v[210:211], v20 offset:54272
buffer_load_dwordx4 v[164:167], v5, s[32:35], s60 offen offset:1024
v_cndmask_b32_dpp v201, v141, v137, vcc quad_perm:[1,0,3,2] row_mask:0xf bank_mask:0xf
v_cndmask_b32_dpp v202, v142, v138, vcc quad_perm:[1,0,3,2] row_mask:0xf bank_mask:0xf
s_waitcnt lgkmcnt(10)
v_mfma_f32_32x32x16_bf16 v[112:127], v[220:223], v[176:179], v[112:127]
ds_read_b64_tr_b16 v[212:213], v21 offset:53248
ds_read_b64_tr_b16 v[214:215], v21 offset:54272
v_cndmask_b32_dpp v203, v143, v139, vcc quad_perm:[1,0,3,2] row_mask:0xf bank_mask:0xf
s_mov_b64 vcc, s[70:71]
v_cndmask_b32_dpp v196, v128, v132, vcc quad_perm:[1,0,3,2] row_mask:0xf bank_mask:0xf
s_waitcnt lgkmcnt(10)
v_mfma_f32_32x32x16_bf16 v[64:79], v[224:227], v[180:183], v[64:79]
ds_read_b64_tr_b16 v[216:217], v22 offset:53248
ds_read_b64_tr_b16 v[218:219], v22 offset:54272
buffer_load_dwordx4 v[168:171], v5, s[32:35], s60 offen offset:2048
v_cndmask_b32_dpp v197, v129, v133, vcc quad_perm:[1,0,3,2] row_mask:0xf bank_mask:0xf
v_cndmask_b32_dpp v198, v130, v134, vcc quad_perm:[1,0,3,2] row_mask:0xf bank_mask:0xf
s_waitcnt lgkmcnt(10)
v_mfma_f32_32x32x16_bf16 v[80:95], v[228:231], v[180:183], v[80:95]
ds_read_b64_tr_b16 v[220:221], v23 offset:53248
ds_read_b64_tr_b16 v[222:223], v23 offset:54272
v_cndmask_b32_dpp v199, v131, v135, vcc quad_perm:[1,0,3,2] row_mask:0xf bank_mask:0xf
v_cndmask_b32_dpp v204, v136, v140, vcc quad_perm:[1,0,3,2] row_mask:0xf bank_mask:0xf
s_waitcnt lgkmcnt(10)
v_mfma_f32_32x32x16_bf16 v[96:111], v[232:235], v[180:183], v[96:111]
ds_read_b64_tr_b16 v[224:225], v20 offset:55296
ds_read_b64_tr_b16 v[226:227], v20 offset:56320
buffer_load_dwordx4 v[172:175], v5, s[32:35], s60 offen offset:3072
v_cndmask_b32_dpp v205, v137, v141, vcc quad_perm:[1,0,3,2] row_mask:0xf bank_mask:0xf
v_cndmask_b32_dpp v206, v138, v142, vcc quad_perm:[1,0,3,2] row_mask:0xf bank_mask:0xf
s_waitcnt lgkmcnt(10)
v_mfma_f32_32x32x16_bf16 v[112:127], v[236:239], v[180:183], v[112:127]
ds_read_b64_tr_b16 v[228:229], v21 offset:55296
ds_read_b64_tr_b16 v[230:231], v21 offset:56320
v_cndmask_b32_dpp v207, v139, v143, vcc quad_perm:[1,0,3,2] row_mask:0xf bank_mask:0xf
s_mov_b64 vcc, s[72:73]
v_cndmask_b32_dpp v128, v200, v192, vcc quad_perm:[2,3,0,1] row_mask:0xf bank_mask:0xf
v_cndmask_b32_dpp v129, v201, v193, vcc quad_perm:[2,3,0,1] row_mask:0xf bank_mask:0xf
s_waitcnt lgkmcnt(10)
v_mfma_f32_32x32x16_bf16 v[64:79], v[208:211], v[184:187], v[64:79]
ds_read_b64_tr_b16 v[232:233], v22 offset:55296
ds_read_b64_tr_b16 v[234:235], v22 offset:56320
s_cmp_lg_u32 s52, 0
s_cbranch_scc1 LF_nc
s_lshl_b32 s62, s2, 8
s_add_u32 s62, s62, 0x1000000
v_mov_b32 v17, 0
v_lshlrev_b32 v18, 2, v1
buffer_store_dword v17, v18, s[48:51], s62 offen sc1
LF_nc:
v_cndmask_b32_dpp v130, v202, v194, vcc quad_perm:[2,3,0,1] row_mask:0xf bank_mask:0xf
v_cndmask_b32_dpp v131, v203, v195, vcc quad_perm:[2,3,0,1] row_mask:0xf bank_mask:0xf
s_waitcnt lgkmcnt(10)
v_mfma_f32_32x32x16_bf16 v[80:95], v[212:215], v[184:187], v[80:95]
ds_read_b64_tr_b16 v[236:237], v23 offset:55296
ds_read_b64_tr_b16 v[238:239], v23 offset:56320
s_waitcnt vmcnt(14)
s_barrier
s_bfe_u32 s60, s67, 0x40018
s_lshl_b32 s60, s60, 19
s_add_u32 s60, s60, s77
s_add_u32 m0, s66, 32768
s_add_u32 s60, s60, 0
buffer_load_dwordx4 v4, s[44:47], s60 offen  lds
v_cndmask_b32_dpp v132, v204, v196, vcc quad_perm:[2,3,0,1] row_mask:0xf bank_mask:0xf
v_cndmask_b32_dpp v133, v205, v197, vcc quad_perm:[2,3,0,1] row_mask:0xf bank_mask:0xf
s_waitcnt lgkmcnt(10)
v_mfma_f32_32x32x16_bf16 v[96:111], v[216:219], v[184:187], v[96:111]
ds_read_b64_tr_b16 v[208:209], v20 offset:0
ds_read_b64_tr_b16 v[210:211], v20 offset:1024
s_add_u32 m0, s66, 33792
s_add_u32 s60, s60, 32768
buffer_load_dwordx4 v4, s[44:47], s60 offen  lds
v_cndmask_b32_dpp v134, v206, v198, vcc quad_perm:[2,3,0,1] row_mask:0xf bank_mask:0xf
v_cndmask_b32_dpp v135, v207, v199, vcc quad_perm:[2,3,0,1] row_mask:0xf bank_mask:0xf
s_waitcnt lgkmcnt(10)
v_mfma_f32_32x32x16_bf16 v[112:127], v[220:223], v[184:187], v[112:127]
ds_read_b64_tr_b16 v[212:213], v21 offset:0
ds_read_b64_tr_b16 v[214:215], v21 offset:1024
s_mov_b64 vcc, s[74:75]
v_cndmask_b32_dpp v136, v192, v200, vcc quad_perm:[2,3,0,1] row_mask:0xf bank_mask:0xf
v_cndmask_b32_dpp v137, v193, v201, vcc quad_perm:[2,3,0,1] row_mask:0xf bank_mask:0xf
s_waitcnt lgkmcnt(10)
v_mfma_f32_32x32x16_bf16 v[64:79], v[224:227], v[188:191], v[64:79]
ds_read_b64_tr_b16 v[216:217], v22 offset:0
ds_read_b64_tr_b16 v[218:219], v22 offset:1024
s_add_u32 m0, s65, 98304
s_add_u32 s59, s58, 16384
buffer_load_dwordx4 v2, s[36:39], s59 offen offset:2048 nt lds
v_cndmask_b32_dpp v138, v194, v202, vcc quad_perm:[2,3,0,1] row_mask:0xf bank_mask:0xf
v_cndmask_b32_dpp v139, v195, v203, vcc quad_perm:[2,3,0,1] row_mask:0xf bank_mask:0xf
s_waitcnt lgkmcnt(10)
v_mfma_f32_32x32x16_bf16 v[80:95], v[228:231], v[188:191], v[80:95]
ds_read_b64_tr_b16 v[220:221], v23 offset:0
ds_read_b64_tr_b16 v[222:223], v23 offset:1024
v_cndmask_b32_dpp v140, v196, v204, vcc quad_perm:[2,3,0,1] row_mask:0xf bank_mask:0xf
v_cndmask_b32_dpp v141, v197, v205, vcc quad_perm:[2,3,0,1] row_mask:0xf bank_mask:0xf
s_waitcnt lgkmcnt(10)
v_mfma_f32_32x32x16_bf16 v[96:111], v[232:235], v[188:191], v[96:111]
ds_read_b64_tr_b16 v[224:225], v20 offset:2048
ds_read_b64_tr_b16 v[226:227], v20 offset:3072
s_add_u32 m0, s65, 98304
s_add_u32 s59, s58, 16384
buffer_load_dwordx4 v2, s[36:39], s59 offen offset:3072 nt lds
v_cndmask_b32_dpp v142, v198, v206, vcc quad_perm:[2,3,0,1] row_mask:0xf bank_mask:0xf
v_cndmask_b32_dpp v143, v199, v207, vcc quad_perm:[2,3,0,1] row_mask:0xf bank_mask:0xf
s_waitcnt lgkmcnt(10)
v_mfma_f32_32x32x16_bf16 v[112:127], v[236:239], v[188:191], v[112:127]
ds_read_b64_tr_b16 v[228:229], v21 offset:2048
ds_read_b64_tr_b16 v[230:231], v21 offset:3072
s_waitcnt vmcnt(12)
s_waitcnt lgkmcnt(10)
v_mfma_f32_32x32x16_bf16 v[64:79], v[208:211], v[128:131], v[64:79]
ds_read_b64_tr_b16 v[232:233], v22 offset:2048
ds_read_b64_tr_b16 v[234:235], v22 offset:3072
s_bfe_u32 s60, s67, 0x4001c
s_lshl_b32 s60, s60, 7
s_add_u32 s60, s60, s76
buffer_load_dwordx4 v[176:179], v5, s[32:35], s60 offen offset:0
s_mov_b64 vcc, s[68:69]
v_cndmask_b32_dpp v192, v148, v144, vcc quad_perm:[1,0,3,2] row_mask:0xf bank_mask:0xf
v_cndmask_b32_dpp v193, v149, v145, vcc quad_perm:[1,0,3,2] row_mask:0xf bank_mask:0xf
v_cndmask_b32_dpp v194, v150, v146, vcc quad_perm:[1,0,3,2] row_mask:0xf bank_mask:0xf
s_waitcnt lgkmcnt(10)
v_mfma_f32_32x32x16_bf16 v[80:95], v[212:215], v[128:131], v[80:95]
ds_read_b64_tr_b16 v[236:237], v23 offset:2048
ds_read_b64_tr_b16 v[238:239], v23 offset:3072
v_cndmask_b32_dpp v195, v151, v147, vcc quad_perm:[1,0,3,2] row_mask:0xf bank_mask:0xf
v_cndmask_b32_dpp v200, v156, v152, vcc quad_perm:[1,0,3,2] row_mask:0xf bank_mask:0xf
s_waitcnt lgkmcnt(10)
v_mfma_f32_32x32x16_bf16 v[96:111], v[216:219], v[128:131], v[96:111]
ds_read_b64_tr_b16 v[208:209], v20 offset:4096
ds_read_b64_tr_b16 v[210:211], v20 offset:5120
buffer_load_dwordx4 v[180:183], v5, s[32:35], s60 offen offset:1024
v_cndmask_b32_dpp v201, v157, v153, vcc quad_perm:[1,0,3,2] row_mask:0xf bank_mask:0xf
v_cndmask_b32_dpp v202, v158, v154, vcc quad_perm:[1,0,3,2] row_mask:0xf bank_mask:0xf
s_waitcnt lgkmcnt(10)
v_mfma_f32_32x32x16_bf16 v[112:127], v[220:223], v[128:131], v[112:127]
ds_read_b64_tr_b16 v[212:213], v21 offset:4096
ds_read_b64_tr_b16 v[214:215], v21 offset:5120
v_cndmask_b32_dpp v203, v159, v155, vcc quad_perm:[1,0,3,2] row_mask:0xf bank_mask:0xf
s_mov_b64 vcc, s[70:71]
v_cndmask_b32_dpp v196, v144, v148, vcc quad_perm:[1,0,3,2] row_mask:0xf bank_mask:0xf
s_waitcnt lgkmcnt(10)
v_mfma_f32_32x32x16_bf16 v[64:79], v[224:227], v[132:135], v[64:79]
ds_read_b64_tr_b16 v[216:217], v22 offset:4096
ds_read_b64_tr_b16 v[218:219], v22 offset:5120
buffer_load_dwordx4 v[184:187], v5, s[32:35], s60 offen offset:2048
v_cndmask_b32_dpp v197, v145, v149, vcc quad_perm:[1,0,3,2] row_mask:0xf bank_mask:0xf
v_cndmask_b32_dpp v198, v146, v150, vcc quad_perm:[1,0,3,2] row_mask:0xf bank_mask:0xf
s_waitcnt lgkmcnt(10)
v_mfma_f32_32x32x16_bf16 v[80:95], v[228:231], v[132:135], v[80:95]
ds_read_b64_tr_b16 v[220:221], v23 offset:4096
ds_read_b64_tr_b16 v[222:223], v23 offset:5120
v_cndmask_b32_dpp v199, v147, v151, vcc quad_perm:[1,0,3,2] row_mask:0xf bank_mask:0xf
v_cndmask_b32_dpp v204, v152, v156, vcc quad_perm:[1,0,3,2] row_mask:0xf bank_mask:0xf
s_waitcnt lgkmcnt(10)
v_mfma_f32_32x32x16_bf16 v[96:111], v[232:235], v[132:135], v[96:111]
ds_read_b64_tr_b16 v[224:225], v20 offset:6144
ds_read_b64_tr_b16 v[226:227], v20 offset:7168
buffer_load_dwordx4 v[188:191], v5, s[32:35], s60 offen offset:3072
v_cndmask_b32_dpp v205, v153, v157, vcc quad_perm:[1,0,3,2] row_mask:0xf bank_mask:0xf
v_cndmask_b32_dpp v206, v154, v158, vcc quad_perm:[1,0,3,2] row_mask:0xf bank_mask:0xf
s_waitcnt lgkmcnt(10)
v_mfma_f32_32x32x16_bf16 v[112:127], v[236:239], v[132:135], v[112:127]
ds_read_b64_tr_b16 v[228:229], v21 offset:6144
ds_read_b64_tr_b16 v[230:231], v21 offset:7168
v_cndmask_b32_dpp v207, v155, v159, vcc quad_perm:[1,0,3,2] row_mask:0xf bank_mask:0xf
s_mov_b64 vcc, s[72:73]
v_cndmask_b32_dpp v144, v200, v192, vcc quad_perm:[2,3,0,1] row_mask:0xf bank_mask:0xf
v_cndmask_b32_dpp v145, v201, v193, vcc quad_perm:[2,3,0,1] row_mask:0xf bank_mask:0xf
s_waitcnt lgkmcnt(10)
v_mfma_f32_32x32x16_bf16 v[64:79], v[208:211], v[136:139], v[64:79]
ds_read_b64_tr_b16 v[232:233], v22 offset:6144
ds_read_b64_tr_b16 v[234:235], v22 offset:7168
v_cndmask_b32_dpp v146, v202, v194, vcc quad_perm:[2,3,0,1] row_mask:0xf bank_mask:0xf
v_cndmask_b32_dpp v147, v203, v195, vcc quad_perm:[2,3,0,1] row_mask:0xf bank_mask:0xf
s_waitcnt lgkmcnt(10)
v_mfma_f32_32x32x16_bf16 v[80:95], v[212:215], v[136:139], v[80:95]
ds_read_b64_tr_b16 v[236:237], v23 offset:6144
ds_read_b64_tr_b16 v[238:239], v23 offset:7168
s_waitcnt vmcnt(14)
s_barrier
s_bfe_u32 s60, s67, 0x4001c
s_lshl_b32 s60, s60, 19
s_add_u32 s60, s60, s77
s_add_u32 m0, s66, 49152
s_add_u32 s60, s60, 0
buffer_load_dwordx4 v4, s[44:47], s60 offen  lds
v_cndmask_b32_dpp v148, v204, v196, vcc quad_perm:[2,3,0,1] row_mask:0xf bank_mask:0xf
v_cndmask_b32_dpp v149, v205, v197, vcc quad_perm:[2,3,0,1] row_mask:0xf bank_mask:0xf
s_waitcnt lgkmcnt(10)
v_mfma_f32_32x32x16_bf16 v[96:111], v[216:219], v[136:139], v[96:111]
ds_read_b64_tr_b16 v[208:209], v20 offset:16384
ds_read_b64_tr_b16 v[210:211], v20 offset:17408
s_add_u32 m0, s66, 50176
s_add_u32 s60, s60, 32768
buffer_load_dwordx4 v4, s[44:47], s60 offen  lds
v_cndmask_b32_dpp v150, v206, v198, vcc quad_perm:[2,3,0,1] row_mask:0xf bank_mask:0xf
v_cndmask_b32_dpp v151, v207, v199, vcc quad_perm:[2,3,0,1] row_mask:0xf bank_mask:0xf
s_waitcnt lgkmcnt(10)
v_mfma_f32_32x32x16_bf16 v[112:127], v[220:223], v[136:139], v[112:127]
ds_read_b64_tr_b16 v[212:213], v21 offset:16384
ds_read_b64_tr_b16 v[214:215], v21 offset:17408
s_mov_b64 vcc, s[74:75]
v_cndmask_b32_dpp v152, v192, v200, vcc quad_perm:[2,3,0,1] row_mask:0xf bank_mask:0xf
v_cndmask_b32_dpp v153, v193, v201, vcc quad_perm:[2,3,0,1] row_mask:0xf bank_mask:0xf
s_waitcnt lgkmcnt(10)
v_mfma_f32_32x32x16_bf16 v[64:79], v[224:227], v[140:143], v[64:79]
ds_read_b64_tr_b16 v[216:217], v22 offset:16384
ds_read_b64_tr_b16 v[218:219], v22 offset:17408
s_add_u32 m0, s65, 131072
s_add_u32 s59, s58, 0
buffer_load_dwordx4 v3, s[40:43], s59 offen offset:0 nt lds
v_cndmask_b32_dpp v154, v194, v202, vcc quad_perm:[2,3,0,1] row_mask:0xf bank_mask:0xf
v_cndmask_b32_dpp v155, v195, v203, vcc quad_perm:[2,3,0,1] row_mask:0xf bank_mask:0xf
s_waitcnt lgkmcnt(10)
v_mfma_f32_32x32x16_bf16 v[80:95], v[228:231], v[140:143], v[80:95]
ds_read_b64_tr_b16 v[220:221], v23 offset:16384
ds_read_b64_tr_b16 v[222:223], v23 offset:17408
v_cndmask_b32_dpp v156, v196, v204, vcc quad_perm:[2,3,0,1] row_mask:0xf bank_mask:0xf
v_cndmask_b32_dpp v157, v197, v205, vcc quad_perm:[2,3,0,1] row_mask:0xf bank_mask:0xf
s_waitcnt lgkmcnt(10)
v_mfma_f32_32x32x16_bf16 v[96:111], v[232:235], v[140:143], v[96:111]
ds_read_b64_tr_b16 v[224:225], v20 offset:18432
ds_read_b64_tr_b16 v[226:227], v20 offset:19456
s_add_u32 m0, s65, 131072
s_add_u32 s59, s58, 0
buffer_load_dwordx4 v3, s[40:43], s59 offen offset:1024 nt lds
v_cndmask_b32_dpp v158, v198, v206, vcc quad_perm:[2,3,0,1] row_mask:0xf bank_mask:0xf
v_cndmask_b32_dpp v159, v199, v207, vcc quad_perm:[2,3,0,1] row_mask:0xf bank_mask:0xf
s_waitcnt lgkmcnt(10)
v_mfma_f32_32x32x16_bf16 v[112:127], v[236:239], v[140:143], v[112:127]
ds_read_b64_tr_b16 v[228:229], v21 offset:18432
ds_read_b64_tr_b16 v[230:231], v21 offset:19456
s_waitcnt vmcnt(12)
s_waitcnt lgkmcnt(10)
v_mfma_f32_32x32x16_bf16 v[64:79], v[208:211], v[144:147], v[64:79]
ds_read_b64_tr_b16 v[232:233], v22 offset:18432
ds_read_b64_tr_b16 v[234:235], v22 offset:19456
s_mov_b64 vcc, s[68:69]
v_cndmask_b32_dpp v192, v164, v160, vcc quad_perm:[1,0,3,2] row_mask:0xf bank_mask:0xf
v_cndmask_b32_dpp v193, v165, v161, vcc quad_perm:[1,0,3,2] row_mask:0xf bank_mask:0xf
v_cndmask_b32_dpp v194, v166, v162, vcc quad_perm:[1,0,3,2] row_mask:0xf bank_mask:0xf
s_waitcnt lgkmcnt(10)
v_mfma_f32_32x32x16_bf16 v[80:95], v[212:215], v[144:147], v[80:95]
ds_read_b64_tr_b16 v[236:237], v23 offset:18432
ds_read_b64_tr_b16 v[238:239], v23 offset:19456
v_cndmask_b32_dpp v195, v167, v163, vcc quad_perm:[1,0,3,2] row_mask:0xf bank_mask:0xf
v_cndmask_b32_dpp v200, v172, v168, vcc quad_perm:[1,0,3,2] row_mask:0xf bank_mask:0xf
s_waitcnt lgkmcnt(10)
v_mfma_f32_32x32x16_bf16 v[96:111], v[216:219], v[144:147], v[96:111]
ds_read_b64_tr_b16 v[208:209], v20 offset:20480
ds_read_b64_tr_b16 v[210:211], v20 offset:21504
v_cndmask_b32_dpp v201, v173, v169, vcc quad_perm:[1,0,3,2] row_mask:0xf bank_mask:0xf
v_cndmask_b32_dpp v202, v174, v170, vcc quad_perm:[1,0,3,2] row_mask:0xf bank_mask:0xf
s_waitcnt lgkmcnt(10)
v_mfma_f32_32x32x16_bf16 v[112:127], v[220:223], v[144:147], v[112:127]
ds_read_b64_tr_b16 v[212:213], v21 offset:20480
ds_read_b64_tr_b16 v[214:215], v21 offset:21504
v_cndmask_b32_dpp v203, v175, v171, vcc quad_perm:[1,0,3,2] row_mask:0xf bank_mask:0xf
s_mov_b64 vcc, s[70:71]
v_cndmask_b32_dpp v196, v160, v164, vcc quad_perm:[1,0,3,2] row_mask:0xf bank_mask:0xf
s_waitcnt lgkmcnt(10)
v_mfma_f32_32x32x16_bf16 v[64:79], v[224:227], v[148:151], v[64:79]
ds_read_b64_tr_b16 v[216:217], v22 offset:20480
ds_read_b64_tr_b16 v[218:219], v22 offset:21504
v_cndmask_b32_dpp v197, v161, v165, vcc quad_perm:[1,0,3,2] row_mask:0xf bank_mask:0xf
v_cndmask_b32_dpp v198, v162, v166, vcc quad_perm:[1,0,3,2] row_mask:0xf bank_mask:0xf
s_waitcnt lgkmcnt(10)
v_mfma_f32_32x32x16_bf16 v[80:95], v[228:231], v[148:151], v[80:95]
ds_read_b64_tr_b16 v[220:221], v23 offset:20480
ds_read_b64_tr_b16 v[222:223], v23 offset:21504
v_cndmask_b32_dpp v199, v163, v167, vcc quad_perm:[1,0,3,2] row_mask:0xf bank_mask:0xf
v_cndmask_b32_dpp v204, v168, v172, vcc quad_perm:[1,0,3,2] row_mask:0xf bank_mask:0xf
s_waitcnt lgkmcnt(10)
v_mfma_f32_32x32x16_bf16 v[96:111], v[232:235], v[148:151], v[96:111]
ds_read_b64_tr_b16 v[224:225], v20 offset:22528
ds_read_b64_tr_b16 v[226:227], v20 offset:23552
v_cndmask_b32_dpp v205, v169, v173, vcc quad_perm:[1,0,3,2] row_mask:0xf bank_mask:0xf
v_cndmask_b32_dpp v206, v170, v174, vcc quad_perm:[1,0,3,2] row_mask:0xf bank_mask:0xf
s_waitcnt lgkmcnt(10)
v_mfma_f32_32x32x16_bf16 v[112:127], v[236:239], v[148:151], v[112:127]
ds_read_b64_tr_b16 v[228:229], v21 offset:22528
ds_read_b64_tr_b16 v[230:231], v21 offset:23552
v_cndmask_b32_dpp v207, v171, v175, vcc quad_perm:[1,0,3,2] row_mask:0xf bank_mask:0xf
s_mov_b64 vcc, s[72:73]
v_cndmask_b32_dpp v160, v200, v192, vcc quad_perm:[2,3,0,1] row_mask:0xf bank_mask:0xf
v_cndmask_b32_dpp v161, v201, v193, vcc quad_perm:[2,3,0,1] row_mask:0xf bank_mask:0xf
s_waitcnt lgkmcnt(10)
v_mfma_f32_32x32x16_bf16 v[64:79], v[208:211], v[152:155], v[64:79]
ds_read_b64_tr_b16 v[232:233], v22 offset:22528
ds_read_b64_tr_b16 v[234:235], v22 offset:23552
v_cndmask_b32_dpp v162, v202, v194, vcc quad_perm:[2,3,0,1] row_mask:0xf bank_mask:0xf
v_cndmask_b32_dpp v163, v203, v195, vcc quad_perm:[2,3,0,1] row_mask:0xf bank_mask:0xf
s_waitcnt lgkmcnt(10)
v_mfma_f32_32x32x16_bf16 v[80:95], v[212:215], v[152:155], v[80:95]
ds_read_b64_tr_b16 v[236:237], v23 offset:22528
ds_read_b64_tr_b16 v[238:239], v23 offset:23552
s_waitcnt vmcnt(10)
s_barrier
s_add_u32 m0, s65, 131072
s_add_u32 s59, s58, 0
buffer_load_dwordx4 v3, s[40:43], s59 offen offset:2048 nt lds
v_cndmask_b32_dpp v164, v204, v196, vcc quad_perm:[2,3,0,1] row_mask:0xf bank_mask:0xf
v_cndmask_b32_dpp v165, v205, v197, vcc quad_perm:[2,3,0,1] row_mask:0xf bank_mask:0xf
s_waitcnt lgkmcnt(10)
v_mfma_f32_32x32x16_bf16 v[96:111], v[216:219], v[152:155], v[96:111]
ds_read_b64_tr_b16 v[208:209], v20 offset:32768
ds_read_b64_tr_b16 v[210:211], v20 offset:33792
v_cndmask_b32_dpp v166, v206, v198, vcc quad_perm:[2,3,0,1] row_mask:0xf bank_mask:0xf
v_cndmask_b32_dpp v167, v207, v199, vcc quad_perm:[2,3,0,1] row_mask:0xf bank_mask:0xf
s_waitcnt lgkmcnt(10)
v_mfma_f32_32x32x16_bf16 v[112:127], v[220:223], v[152:155], v[112:127]
ds_read_b64_tr_b16 v[212:213], v21 offset:32768
ds_read_b64_tr_b16 v[214:215], v21 offset:33792
s_mov_b64 vcc, s[74:75]
v_cndmask_b32_dpp v168, v192, v200, vcc quad_perm:[2,3,0,1] row_mask:0xf bank_mask:0xf
v_cndmask_b32_dpp v169, v193, v201, vcc quad_perm:[2,3,0,1] row_mask:0xf bank_mask:0xf
s_waitcnt lgkmcnt(10)
v_mfma_f32_32x32x16_bf16 v[64:79], v[224:227], v[156:159], v[64:79]
ds_read_b64_tr_b16 v[216:217], v22 offset:32768
ds_read_b64_tr_b16 v[218:219], v22 offset:33792
s_add_u32 m0, s65, 131072
s_add_u32 s59, s58, 0
buffer_load_dwordx4 v3, s[40:43], s59 offen offset:3072 nt lds
v_cndmask_b32_dpp v170, v194, v202, vcc quad_perm:[2,3,0,1] row_mask:0xf bank_mask:0xf
v_cndmask_b32_dpp v171, v195, v203, vcc quad_perm:[2,3,0,1] row_mask:0xf bank_mask:0xf
s_waitcnt lgkmcnt(10)
v_mfma_f32_32x32x16_bf16 v[80:95], v[228:231], v[156:159], v[80:95]
ds_read_b64_tr_b16 v[220:221], v23 offset:32768
ds_read_b64_tr_b16 v[222:223], v23 offset:33792
v_cndmask_b32_dpp v172, v196, v204, vcc quad_perm:[2,3,0,1] row_mask:0xf bank_mask:0xf
v_cndmask_b32_dpp v173, v197, v205, vcc quad_perm:[2,3,0,1] row_mask:0xf bank_mask:0xf
s_waitcnt lgkmcnt(10)
v_mfma_f32_32x32x16_bf16 v[96:111], v[232:235], v[156:159], v[96:111]
ds_read_b64_tr_b16 v[224:225], v20 offset:34816
ds_read_b64_tr_b16 v[226:227], v20 offset:35840
v_cndmask_b32_dpp v174, v198, v206, vcc quad_perm:[2,3,0,1] row_mask:0xf bank_mask:0xf
v_cndmask_b32_dpp v175, v199, v207, vcc quad_perm:[2,3,0,1] row_mask:0xf bank_mask:0xf
s_waitcnt lgkmcnt(10)
v_mfma_f32_32x32x16_bf16 v[112:127], v[236:239], v[156:159], v[112:127]
ds_read_b64_tr_b16 v[228:229], v21 offset:34816
ds_read_b64_tr_b16 v[230:231], v21 offset:35840
s_waitcnt vmcnt(6)
s_waitcnt lgkmcnt(10)
v_mfma_f32_32x32x16_bf16 v[64:79], v[208:211], v[160:163], v[64:79]
ds_read_b64_tr_b16 v[232:233], v22 offset:34816
ds_read_b64_tr_b16 v[234:235], v22 offset:35840
s_mov_b64 vcc, s[68:69]
v_cndmask_b32_dpp v192, v180, v176, vcc quad_perm:[1,0,3,2] row_mask:0xf bank_mask:0xf
v_cndmask_b32_dpp v193, v181, v177, vcc quad_perm:[1,0,3,2] row_mask:0xf bank_mask:0xf
v_cndmask_b32_dpp v194, v182, v178, vcc quad_perm:[1,0,3,2] row_mask:0xf bank_mask:0xf
s_waitcnt lgkmcnt(10)
v_mfma_f32_32x32x16_bf16 v[80:95], v[212:215], v[160:163], v[80:95]
ds_read_b64_tr_b16 v[236:237], v23 offset:34816
ds_read_b64_tr_b16 v[238:239], v23 offset:35840
v_cndmask_b32_dpp v195, v183, v179, vcc quad_perm:[1,0,3,2] row_mask:0xf bank_mask:0xf
v_cndmask_b32_dpp v200, v188, v184, vcc quad_perm:[1,0,3,2] row_mask:0xf bank_mask:0xf
s_waitcnt lgkmcnt(10)
v_mfma_f32_32x32x16_bf16 v[96:111], v[216:219], v[160:163], v[96:111]
ds_read_b64_tr_b16 v[208:209], v20 offset:36864
ds_read_b64_tr_b16 v[210:211], v20 offset:37888
v_cndmask_b32_dpp v201, v189, v185, vcc quad_perm:[1,0,3,2] row_mask:0xf bank_mask:0xf
v_cndmask_b32_dpp v202, v190, v186, vcc quad_perm:[1,0,3,2] row_mask:0xf bank_mask:0xf
s_waitcnt lgkmcnt(10)
v_mfma_f32_32x32x16_bf16 v[112:127], v[220:223], v[160:163], v[112:127]
ds_read_b64_tr_b16 v[212:213], v21 offset:36864
ds_read_b64_tr_b16 v[214:215], v21 offset:37888
v_cndmask_b32_dpp v203, v191, v187, vcc quad_perm:[1,0,3,2] row_mask:0xf bank_mask:0xf
s_mov_b64 vcc, s[70:71]
v_cndmask_b32_dpp v196, v176, v180, vcc quad_perm:[1,0,3,2] row_mask:0xf bank_mask:0xf
s_waitcnt lgkmcnt(10)
v_mfma_f32_32x32x16_bf16 v[64:79], v[224:227], v[164:167], v[64:79]
ds_read_b64_tr_b16 v[216:217], v22 offset:36864
ds_read_b64_tr_b16 v[218:219], v22 offset:37888
v_cndmask_b32_dpp v197, v177, v181, vcc quad_perm:[1,0,3,2] row_mask:0xf bank_mask:0xf
v_cndmask_b32_dpp v198, v178, v182, vcc quad_perm:[1,0,3,2] row_mask:0xf bank_mask:0xf
s_waitcnt lgkmcnt(10)
v_mfma_f32_32x32x16_bf16 v[80:95], v[228:231], v[164:167], v[80:95]
ds_read_b64_tr_b16 v[220:221], v23 offset:36864
ds_read_b64_tr_b16 v[222:223], v23 offset:37888
v_cndmask_b32_dpp v199, v179, v183, vcc quad_perm:[1,0,3,2] row_mask:0xf bank_mask:0xf
v_cndmask_b32_dpp v204, v184, v188, vcc quad_perm:[1,0,3,2] row_mask:0xf bank_mask:0xf
s_waitcnt lgkmcnt(10)
v_mfma_f32_32x32x16_bf16 v[96:111], v[232:235], v[164:167], v[96:111]
ds_read_b64_tr_b16 v[224:225], v20 offset:38912
ds_read_b64_tr_b16 v[226:227], v20 offset:39936
v_cndmask_b32_dpp v205, v185, v189, vcc quad_perm:[1,0,3,2] row_mask:0xf bank_mask:0xf
v_cndmask_b32_dpp v206, v186, v190, vcc quad_perm:[1,0,3,2] row_mask:0xf bank_mask:0xf
s_waitcnt lgkmcnt(10)
v_mfma_f32_32x32x16_bf16 v[112:127], v[236:239], v[164:167], v[112:127]
ds_read_b64_tr_b16 v[228:229], v21 offset:38912
ds_read_b64_tr_b16 v[230:231], v21 offset:39936
v_cndmask_b32_dpp v207, v187, v191, vcc quad_perm:[1,0,3,2] row_mask:0xf bank_mask:0xf
s_mov_b64 vcc, s[72:73]
v_cndmask_b32_dpp v176, v200, v192, vcc quad_perm:[2,3,0,1] row_mask:0xf bank_mask:0xf
v_cndmask_b32_dpp v177, v201, v193, vcc quad_perm:[2,3,0,1] row_mask:0xf bank_mask:0xf
s_waitcnt lgkmcnt(10)
v_mfma_f32_32x32x16_bf16 v[64:79], v[208:211], v[168:171], v[64:79]
ds_read_b64_tr_b16 v[232:233], v22 offset:38912
ds_read_b64_tr_b16 v[234:235], v22 offset:39936
v_cndmask_b32_dpp v178, v202, v194, vcc quad_perm:[2,3,0,1] row_mask:0xf bank_mask:0xf
v_cndmask_b32_dpp v179, v203, v195, vcc quad_perm:[2,3,0,1] row_mask:0xf bank_mask:0xf
s_waitcnt lgkmcnt(10)
v_mfma_f32_32x32x16_bf16 v[80:95], v[212:215], v[168:171], v[80:95]
ds_read_b64_tr_b16 v[236:237], v23 offset:38912
ds_read_b64_tr_b16 v[238:239], v23 offset:39936
s_waitcnt vmcnt(4)
s_barrier
s_add_u32 m0, s65, 0
s_add_u32 s59, s58, 32768
buffer_load_dwordx4 v2, s[36:39], s59 offen offset:0 nt lds
v_cndmask_b32_dpp v180, v204, v196, vcc quad_perm:[2,3,0,1] row_mask:0xf bank_mask:0xf
v_cndmask_b32_dpp v181, v205, v197, vcc quad_perm:[2,3,0,1] row_mask:0xf bank_mask:0xf
s_waitcnt lgkmcnt(10)
v_mfma_f32_32x32x16_bf16 v[96:111], v[216:219], v[168:171], v[96:111]
ds_read_b64_tr_b16 v[208:209], v20 offset:49152
ds_read_b64_tr_b16 v[210:211], v20 offset:50176
v_cndmask_b32_dpp v182, v206, v198, vcc quad_perm:[2,3,0,1] row_mask:0xf bank_mask:0xf
v_cndmask_b32_dpp v183, v207, v199, vcc quad_perm:[2,3,0,1] row_mask:0xf bank_mask:0xf
s_waitcnt lgkmcnt(10)
v_mfma_f32_32x32x16_bf16 v[112:127], v[220:223], v[168:171], v[112:127]
ds_read_b64_tr_b16 v[212:213], v20 offset:51200
ds_read_b64_tr_b16 v[214:215], v20 offset:52224
s_mov_b64 vcc, s[74:75]
v_cndmask_b32_dpp v184, v192, v200, vcc quad_perm:[2,3,0,1] row_mask:0xf bank_mask:0xf
v_cndmask_b32_dpp v185, v193, v201, vcc quad_perm:[2,3,0,1] row_mask:0xf bank_mask:0xf
s_waitcnt lgkmcnt(10)
v_mfma_f32_32x32x16_bf16 v[64:79], v[224:227], v[172:175], v[64:79]
ds_read_b64_tr_b16 v[216:217], v20 offset:53248
ds_read_b64_tr_b16 v[218:219], v20 offset:54272
s_add_u32 m0, s65, 0
s_add_u32 s59, s58, 32768
buffer_load_dwordx4 v2, s[36:39], s59 offen offset:1024 nt lds
v_cndmask_b32_dpp v186, v194, v202, vcc quad_perm:[2,3,0,1] row_mask:0xf bank_mask:0xf
v_cndmask_b32_dpp v187, v195, v203, vcc quad_perm:[2,3,0,1] row_mask:0xf bank_mask:0xf
s_waitcnt lgkmcnt(10)
v_mfma_f32_32x32x16_bf16 v[80:95], v[228:231], v[172:175], v[80:95]
ds_read_b64_tr_b16 v[220:221], v20 offset:55296
ds_read_b64_tr_b16 v[222:223], v20 offset:56320
v_cndmask_b32_dpp v188, v196, v204, vcc quad_perm:[2,3,0,1] row_mask:0xf bank_mask:0xf
v_cndmask_b32_dpp v189, v197, v205, vcc quad_perm:[2,3,0,1] row_mask:0xf bank_mask:0xf
s_waitcnt lgkmcnt(10)
v_mfma_f32_32x32x16_bf16 v[96:111], v[232:235], v[172:175], v[96:111]
ds_read_b64_tr_b16 v[224:225], v21 offset:49152
ds_read_b64_tr_b16 v[226:227], v21 offset:50176
v_cndmask_b32_dpp v190, v198, v206, vcc quad_perm:[2,3,0,1] row_mask:0xf bank_mask:0xf
v_cndmask_b32_dpp v191, v199, v207, vcc quad_perm:[2,3,0,1] row_mask:0xf bank_mask:0xf
s_waitcnt lgkmcnt(10)
v_mfma_f32_32x32x16_bf16 v[112:127], v[236:239], v[172:175], v[112:127]
ds_read_b64_tr_b16 v[228:229], v21 offset:51200
ds_read_b64_tr_b16 v[230:231], v21 offset:52224
s_waitcnt lgkmcnt(10)
v_mfma_f32_32x32x16_bf16 v[64:79], v[208:211], v[176:179], v[64:79]
ds_read_b64_tr_b16 v[232:233], v21 offset:53248
ds_read_b64_tr_b16 v[234:235], v21 offset:54272
s_waitcnt lgkmcnt(10)
v_mfma_f32_32x32x16_bf16 v[64:79], v[212:215], v[180:183], v[64:79]
ds_read_b64_tr_b16 v[236:237], v21 offset:55296
ds_read_b64_tr_b16 v[238:239], v21 offset:56320
s_waitcnt lgkmcnt(10)
v_mfma_f32_32x32x16_bf16 v[64:79], v[216:219], v[184:187], v[64:79]
ds_read_b64_tr_b16 v[208:209], v22 offset:49152
ds_read_b64_tr_b16 v[210:211], v22 offset:50176
s_waitcnt lgkmcnt(10)
v_mfma_f32_32x32x16_bf16 v[64:79], v[220:223], v[188:191], v[64:79]
ds_read_b64_tr_b16 v[212:213], v22 offset:51200
ds_read_b64_tr_b16 v[214:215], v22 offset:52224
s_waitcnt lgkmcnt(10)
v_mfma_f32_32x32x16_bf16 v[80:95], v[224:227], v[176:179], v[80:95]
ds_read_b64_tr_b16 v[216:217], v22 offset:53248
ds_read_b64_tr_b16 v[218:219], v22 offset:54272
s_waitcnt lgkmcnt(10)
v_mfma_f32_32x32x16_bf16 v[80:95], v[228:231], v[180:183], v[80:95]
ds_read_b64_tr_b16 v[220:221], v22 offset:55296
ds_read_b64_tr_b16 v[222:223], v22 offset:56320
v_mul_f32 v64, s64, v64
v_mul_f32 v65, s64, v65
v_mul_f32 v66, s64, v66
v_mul_f32 v67, s64, v67
v_mul_f32 v68, s64, v68
v_mul_f32 v69, s64, v69
v_mul_f32 v70, s64, v70
s_waitcnt lgkmcnt(10)
v_mfma_f32_32x32x16_bf16 v[80:95], v[232:235], v[184:187], v[80:95]
ds_read_b64_tr_b16 v[224:225], v23 offset:49152
ds_read_b64_tr_b16 v[226:227], v23 offset:50176
v_mul_f32 v71, s64, v71
v_mul_f32 v72, s64, v72
v_mul_f32 v73, s64, v73
v_mul_f32 v74, s64, v74
v_mul_f32 v75, s64, v75
v_mul_f32 v76, s64, v76
v_mul_f32 v77, s64, v77
s_waitcnt lgkmcnt(10)
v_mfma_f32_32x32x16_bf16 v[80:95], v[236:239], v[188:191], v[80:95]
ds_read_b64_tr_b16 v[228:229], v23 offset:51200
ds_read_b64_tr_b16 v[230:231], v23 offset:52224
v_mul_f32 v78, s64, v78
v_mul_f32 v79, s64, v79
v_cvt_pk_bf16_f32 v32, v64, v65
v_cvt_pk_bf16_f32 v33, v66, v67
v_cvt_pk_bf16_f32 v34, v68, v69
v_cvt_pk_bf16_f32 v35, v70, v71
s_waitcnt lgkmcnt(10)
v_mfma_f32_32x32x16_bf16 v[96:111], v[208:211], v[176:179], v[96:111]
ds_read_b64_tr_b16 v[232:233], v23 offset:53248
ds_read_b64_tr_b16 v[234:235], v23 offset:54272
v_cvt_pk_bf16_f32 v36, v72, v73
v_cvt_pk_bf16_f32 v37, v74, v75
v_cvt_pk_bf16_f32 v38, v76, v77
v_cvt_pk_bf16_f32 v39, v78, v79
s_waitcnt lgkmcnt(10)
v_mfma_f32_32x32x16_bf16 v[96:111], v[212:215], v[180:183], v[96:111]
ds_read_b64_tr_b16 v[236:237], v23 offset:55296
ds_read_b64_tr_b16 v[238:239], v23 offset:56320
v_add_u32 v24, 65536, v6
v_xor_b32 v25, 32, v24
v_xor_b32 v26, 64, v24
v_xor_b32 v27, 96, v24
v_xor_b32 v28, 128, v24
v_xor_b32 v29, 160, v24
v_xor_b32 v30, 192, v24
v_xor_b32 v31, 224, v24
s_barrier
s_add_u32 m0, s65, 0
s_add_u32 s59, s58, 32768
buffer_load_dwordx4 v2, s[36:39], s59 offen offset:2048 nt lds
v_mul_f32 v80, s64, v80
v_mul_f32 v81, s64, v81
v_mul_f32 v82, s64, v82
v_mul_f32 v83, s64, v83
v_mul_f32 v84, s64, v84
v_mul_f32 v85, s64, v85
v_mul_f32 v86, s64, v86
v_mul_f32 v87, s64, v87
v_mul_f32 v88, s64, v88
s_waitcnt lgkmcnt(10)
v_mfma_f32_32x32x16_bf16 v[96:111], v[216:219], v[184:187], v[96:111]
ds_read_b128 v[208:211], v24 offset:0
v_mul_f32 v89, s64, v89
v_mul_f32 v90, s64, v90
v_mul_f32 v91, s64, v91
v_mul_f32 v92, s64, v92
v_mul_f32 v93, s64, v93
v_mul_f32 v94, s64, v94
v_mul_f32 v95, s64, v95
s_waitcnt lgkmcnt(9)
v_mfma_f32_32x32x16_bf16 v[96:111], v[220:223], v[188:191], v[96:111]
ds_read_b128 v[212:215], v25 offset:0
v_cvt_pk_bf16_f32 v40, v80, v81
v_cvt_pk_bf16_f32 v41, v82, v83
v_cvt_pk_bf16_f32 v42, v84, v85
v_cvt_pk_bf16_f32 v43, v86, v87
v_cvt_pk_bf16_f32 v44, v88, v89
v_cvt_pk_bf16_f32 v45, v90, v91
s_waitcnt lgkmcnt(8)
v_mfma_f32_32x32x16_bf16 v[112:127], v[224:227], v[176:179], v[112:127]
ds_read_b128 v[216:219], v26 offset:0
s_add_u32 m0, s65, 0
s_add_u32 s59, s58, 32768
buffer_load_dwordx4 v2, s[36:39], s59 offen offset:3072 nt lds
v_cvt_pk_bf16_f32 v46, v92, v93
v_cvt_pk_bf16_f32 v47, v94, v95
s_waitcnt lgkmcnt(7)
v_mfma_f32_32x32x16_bf16 v[112:127], v[228:231], v[180:183], v[112:127]
ds_read_b128 v[220:223], v27 offset:0
v_mul_f32 v96, s64, v96
v_mul_f32 v97, s64, v97
v_mul_f32 v98, s64, v98
v_mul_f32 v99, s64, v99
v_mul_f32 v100, s64, v100
v_mul_f32 v101, s64, v101
v_mul_f32 v102, s64, v102
v_mul_f32 v103, s64, v103
v_mul_f32 v104, s64, v104
v_mul_f32 v105, s64, v105
v_mul_f32 v106, s64, v106
s_waitcnt lgkmcnt(6)
v_mfma_f32_32x32x16_bf16 v[112:127], v[232:235], v[184:187], v[112:127]
ds_read_b128 v[224:227], v28 offset:0
v_mul_f32 v107, s64, v107
v_mul_f32 v108, s64, v108
v_mul_f32 v109, s64, v109
v_mul_f32 v110, s64, v110
v_mul_f32 v111, s64, v111
v_cvt_pk_bf16_f32 v48, v96, v97
v_cvt_pk_bf16_f32 v49, v98, v99
s_waitcnt lgkmcnt(5)
v_mfma_f32_32x32x16_bf16 v[112:127], v[236:239], v[188:191], v[112:127]
ds_read_b128 v[228:231], v29 offset:0
v_cvt_pk_bf16_f32 v50, v100, v101
v_cvt_pk_bf16_f32 v51, v102, v103
v_cvt_pk_bf16_f32 v52, v104, v105
v_cvt_pk_bf16_f32 v53, v106, v107
v_cvt_pk_bf16_f32 v54, v108, v109
v_cvt_pk_bf16_f32 v55, v110, v111
s_waitcnt lgkmcnt(5)
v_mfma_f32_32x32x16_bf16 v[128:143], v[208:211], v[32:35], 0
ds_read_b128 v[232:235], v30 offset:0
s_waitcnt lgkmcnt(5)
v_mfma_f32_32x32x16_bf16 v[128:143], v[212:215], v[36:39], v[128:143]
ds_read_b128 v[236:239], v31 offset:0
v_mul_f32 v112, s64, v112
v_mul_f32 v113, s64, v113
v_mul_f32 v114, s64, v114
v_mul_f32 v115, s64, v115
v_mul_f32 v116, s64, v116
v_mul_f32 v117, s64, v117
v_mul_f32 v118, s64, v118
v_mul_f32 v119, s64, v119
s_waitcnt lgkmcnt(5)
v_mfma_f32_32x32x16_bf16 v[128:143], v[216:219], v[40:43], v[128:143]
ds_read_b128 v[208:211], v24 offset:2048
v_mul_f32 v120, s64, v120
v_mul_f32 v121, s64, v121
v_mul_f32 v122, s64, v122
v_mul_f32 v123, s64, v123
v_mul_f32 v124, s64, v124
v_mul_f32 v125, s64, v125
v_mul_f32 v126, s64, v126
v_mul_f32 v127, s64, v127
s_waitcnt lgkmcnt(5)
v_mfma_f32_32x32x16_bf16 v[128:143], v[220:223], v[44:47], v[128:143]
ds_read_b128 v[212:215], v25 offset:2048
v_cvt_pk_bf16_f32 v56, v112, v113
v_cvt_pk_bf16_f32 v57, v114, v115
v_cvt_pk_bf16_f32 v58, v116, v117
v_cvt_pk_bf16_f32 v59, v118, v119
v_cvt_pk_bf16_f32 v60, v120, v121
v_cvt_pk_bf16_f32 v61, v122, v123
v_cvt_pk_bf16_f32 v62, v124, v125
v_cvt_pk_bf16_f32 v63, v126, v127
s_waitcnt lgkmcnt(5)
v_mfma_f32_32x32x16_bf16 v[128:143], v[224:227], v[48:51], v[128:143]
ds_read_b128 v[216:219], v26 offset:2048
s_waitcnt lgkmcnt(5)
v_mfma_f32_32x32x16_bf16 v[128:143], v[228:231], v[52:55], v[128:143]
ds_read_b128 v[220:223], v27 offset:2048
s_waitcnt lgkmcnt(5)
v_mfma_f32_32x32x16_bf16 v[128:143], v[232:235], v[56:59], v[128:143]
ds_read_b128 v[224:227], v28 offset:2048
s_waitcnt lgkmcnt(5)
v_mfma_f32_32x32x16_bf16 v[128:143], v[236:239], v[60:63], v[128:143]
ds_read_b128 v[228:231], v29 offset:2048
s_waitcnt lgkmcnt(5)
v_mfma_f32_32x32x16_bf16 v[144:159], v[208:211], v[32:35], 0
ds_read_b128 v[232:235], v30 offset:2048
s_waitcnt lgkmcnt(5)
v_mfma_f32_32x32x16_bf16 v[144:159], v[212:215], v[36:39], v[144:159]
ds_read_b128 v[236:239], v31 offset:2048
s_barrier
s_add_u32 m0, s65, 32768
s_add_u32 s59, s58, 16384
buffer_load_dwordx4 v3, s[40:43], s59 offen offset:0 nt lds
s_waitcnt lgkmcnt(5)
v_mfma_f32_32x32x16_bf16 v[144:159], v[216:219], v[40:43], v[144:159]
ds_read_b128 v[208:211], v24 offset:32768
v_max3_f32 v13, v128, v129, v130
v_max3_f32 v13, v131, v132, v13
v_max3_f32 v13, v133, v134, v13
v_max3_f32 v13, v135, v136, v13
v_max3_f32 v13, v137, v138, v13
v_max3_f32 v13, v139, v140, v13
v_max3_f32 v13, v141, v142, v13
s_waitcnt lgkmcnt(5)
v_mfma_f32_32x32x16_bf16 v[144:159], v[220:223], v[44:47], v[144:159]
ds_read_b128 v[212:215], v25 offset:32768
s_waitcnt lgkmcnt(5)
v_mfma_f32_32x32x16_bf16 v[144:159], v[224:227], v[48:51], v[144:159]
ds_read_b128 v[216:219], v26 offset:32768
s_waitcnt lgkmcnt(5)
v_mfma_f32_32x32x16_bf16 v[144:159], v[228:231], v[52:55], v[144:159]
ds_read_b128 v[220:223], v27 offset:32768
s_add_u32 m0, s65, 32768
s_add_u32 s59, s58, 16384
buffer_load_dwordx4 v3, s[40:43], s59 offen offset:1024 nt lds
s_waitcnt lgkmcnt(5)
v_mfma_f32_32x32x16_bf16 v[144:159], v[232:235], v[56:59], v[144:159]
ds_read_b128 v[224:227], v28 offset:32768
s_waitcnt lgkmcnt(5)
v_mfma_f32_32x32x16_bf16 v[144:159], v[236:239], v[60:63], v[144:159]
ds_read_b128 v[228:231], v29 offset:32768
s_nop 7
s_nop 3
v_max3_f32 v14, v144, v145, v143
v_max3_f32 v14, v146, v147, v14
v_max3_f32 v14, v148, v149, v14
v_max3_f32 v14, v150, v151, v14
v_max3_f32 v14, v152, v153, v14
v_max3_f32 v14, v154, v155, v14
v_max3_f32 v14, v156, v157, v14
v_max3_f32 v14, v158, v159, v14
v_max_f32 v13, v13, v14
v_mov_b32 v14, v13
s_nop 1
v_permlane32_swap_b32 v13, v14
s_nop 1
v_max_f32 v13, v13, v14
v_sub_f32 v240, 0, v13
v_sub_f32 v241, 0, v13
v_sub_f32 v242, 0, v13
v_sub_f32 v243, 0, v13
v_sub_f32 v244, 0, v13
v_sub_f32 v245, 0, v13
v_sub_f32 v246, 0, v13
v_sub_f32 v247, 0, v13
v_sub_f32 v248, 0, v13
v_sub_f32 v249, 0, v13
v_sub_f32 v250, 0, v13
v_sub_f32 v251, 0, v13
v_sub_f32 v252, 0, v13
v_sub_f32 v253, 0, v13
v_sub_f32 v254, 0, v13
v_sub_f32 v255, 0, v13
s_nop 1
s_waitcnt lgkmcnt(5)
v_mfma_f32_32x32x16_bf16 v[160:175], v[208:211], v[32:35], v[240:255]
ds_read_b128 v[232:235], v30 offset:32768
v_sub_f32 v128, v128, v13
v_sub_f32 v129, v129, v13
v_exp_f32 v128, v128
v_exp_f32 v129, v129
v_sub_f32 v130, v130, v13
v_sub_f32 v131, v131, v13
v_exp_f32 v130, v130
s_waitcnt lgkmcnt(5)
v_mfma_f32_32x32x16_bf16 v[160:175], v[212:215], v[36:39], v[160:175]
ds_read_b128 v[236:239], v31 offset:32768
s_add_u32 m0, s65, 32768
s_add_u32 s59, s58, 16384
buffer_load_dwordx4 v3, s[40:43], s59 offen offset:2048 nt lds
v_exp_f32 v131, v131
v_mov_b32 v10, v128
v_mov_b32 v11, v129
v_cvt_pk_bf16_f32 v192, v128, v129
v_sub_f32 v132, v132, v13
v_sub_f32 v133, v133, v13
v_exp_f32 v132, v132
v_exp_f32 v133, v133
s_waitcnt lgkmcnt(5)
v_mfma_f32_32x32x16_bf16 v[160:175], v[216:219], v[40:43], v[160:175]
ds_read_b128 v[208:211], v24 offset:34816
v_add_f32 v10, v10, v130
v_add_f32 v11, v11, v131
v_cvt_pk_bf16_f32 v193, v130, v131
v_sub_f32 v134, v134, v13
v_sub_f32 v135, v135, v13
v_exp_f32 v134, v134
v_exp_f32 v135, v135
s_waitcnt lgkmcnt(5)
v_mfma_f32_32x32x16_bf16 v[160:175], v[220:223], v[44:47], v[160:175]
ds_read_b128 v[212:215], v25 offset:34816
v_add_f32 v10, v10, v132
v_add_f32 v11, v11, v133
v_cvt_pk_bf16_f32 v194, v132, v133
v_sub_f32 v136, v136, v13
v_sub_f32 v137, v137, v13
v_exp_f32 v136, v136
v_exp_f32 v137, v137
s_waitcnt lgkmcnt(5)
v_mfma_f32_32x32x16_bf16 v[160:175], v[224:227], v[48:51], v[160:175]
ds_read_b128 v[216:219], v26 offset:34816
v_add_f32 v10, v10, v134
v_add_f32 v11, v11, v135
v_cvt_pk_bf16_f32 v195, v134, v135
v_sub_f32 v138, v138, v13
v_sub_f32 v139, v139, v13
v_exp_f32 v138, v138
v_exp_f32 v139, v139
s_waitcnt lgkmcnt(5)
v_mfma_f32_32x32x16_bf16 v[160:175], v[228:231], v[52:55], v[160:175]
ds_read_b128 v[220:223], v27 offset:34816
s_add_u32 m0, s65, 32768
s_add_u32 s59, s58, 16384
buffer_load_dwordx4 v3, s[40:43], s59 offen offset:3072 nt lds
v_add_f32 v10, v10, v136
v_add_f32 v11, v11, v137
v_cvt_pk_bf16_f32 v196, v136, v137
v_sub_f32 v140, v140, v13
v_sub_f32 v141, v141, v13
v_exp_f32 v140, v140
v_exp_f32 v141, v141
v_add_f32 v10, v10, v138
s_waitcnt lgkmcnt(5)
v_mfma_f32_32x32x16_bf16 v[160:175], v[232:235], v[56:59], v[160:175]
ds_read_b128 v[224:227], v28 offset:34816
v_add_f32 v11, v11, v139
v_cvt_pk_bf16_f32 v197, v138, v139
v_sub_f32 v142, v142, v13
v_sub_f32 v143, v143, v13
v_exp_f32 v142, v142
v_exp_f32 v143, v143
v_add_f32 v10, v10, v140
v_add_f32 v11, v11, v141
s_waitcnt lgkmcnt(5)
v_mfma_f32_32x32x16_bf16 v[160:175], v[236:239], v[60:63], v[160:175]
ds_read_b128 v[228:231], v29 offset:34816
v_cvt_pk_bf16_f32 v198, v140, v141
v_sub_f32 v144, v144, v13
v_sub_f32 v145, v145, v13
v_exp_f32 v144, v144
v_exp_f32 v145, v145
v_add_f32 v10, v10, v142
v_add_f32 v11, v11, v143
s_waitcnt lgkmcnt(5)
v_mfma_f32_32x32x16_bf16 v[176:191], v[208:211], v[32:35], v[240:255]
ds_read_b128 v[232:235], v30 offset:34816
v_cvt_pk_bf16_f32 v199, v142, v143
v_sub_f32 v146, v146, v13
v_sub_f32 v147, v147, v13
v_exp_f32 v146, v146
v_exp_f32 v147, v147
v_add_f32 v10, v10, v144
v_add_f32 v11, v11, v145
v_cvt_pk_bf16_f32 v200, v144, v145
s_waitcnt lgkmcnt(5)
v_mfma_f32_32x32x16_bf16 v[176:191], v[212:215], v[36:39], v[176:191]
ds_read_b128 v[236:239], v31 offset:34816
v_add_u32 v20, 131072, v7
v_xor_b32 v21, 64, v20
v_xor_b32 v22, 128, v20
v_xor_b32 v23, 192, v20
s_waitcnt vmcnt(8)
s_barrier
s_add_u32 m0, s65, 65536
s_add_u32 s59, s58, 49152
buffer_load_dwordx4 v2, s[36:39], s59 offen offset:0 nt lds
v_sub_f32 v148, v148, v13
v_sub_f32 v149, v149, v13
v_exp_f32 v148, v148
v_exp_f32 v149, v149
v_add_f32 v10, v10, v146
v_add_f32 v11, v11, v147
v_cvt_pk_bf16_f32 v201, v146, v147
s_waitcnt lgkmcnt(5)
v_mfma_f32_32x32x16_bf16 v[176:191], v[216:219], v[40:43], v[176:191]
ds_read_b64_tr_b16 v[208:209], v20 offset:0
ds_read_b64_tr_b16 v[210:211], v20 offset:8192
v_sub_f32 v150, v150, v13
v_sub_f32 v151, v151, v13
v_exp_f32 v150, v150
v_exp_f32 v151, v151
v_add_f32 v10, v10, v148
v_add_f32 v11, v11, v149
v_cvt_pk_bf16_f32 v202, v148, v149
v_sub_f32 v152, v152, v13
s_waitcnt lgkmcnt(6)
v_mfma_f32_32x32x16_bf16 v[176:191], v[220:223], v[44:47], v[176:191]
ds_read_b64_tr_b16 v[212:213], v21 offset:0
ds_read_b64_tr_b16 v[214:215], v21 offset:8192
v_sub_f32 v153, v153, v13
v_exp_f32 v152, v152
v_exp_f32 v153, v153
v_add_f32 v10, v10, v150
v_add_f32 v11, v11, v151
v_cvt_pk_bf16_f32 v203, v150, v151
v_sub_f32 v154, v154, v13
v_sub_f32 v155, v155, v13
s_waitcnt lgkmcnt(7)
v_mfma_f32_32x32x16_bf16 v[176:191], v[224:227], v[48:51], v[176:191]
ds_read_b64_tr_b16 v[216:217], v22 offset:0
ds_read_b64_tr_b16 v[218:219], v22 offset:8192
v_exp_f32 v154, v154
v_exp_f32 v155, v155
v_add_f32 v10, v10, v152
v_add_f32 v11, v11, v153
v_cvt_pk_bf16_f32 v204, v152, v153
v_sub_f32 v156, v156, v13
v_sub_f32 v157, v157, v13
s_waitcnt lgkmcnt(8)
v_mfma_f32_32x32x16_bf16 v[176:191], v[228:231], v[52:55], v[176:191]
ds_read_b64_tr_b16 v[220:221], v23 offset:0
ds_read_b64_tr_b16 v[222:223], v23 offset:8192
s_add_u32 m0, s65, 65536
s_add_u32 s59, s58, 49152
buffer_load_dwordx4 v2, s[36:39], s59 offen offset:1024 nt lds
v_exp_f32 v156, v156
v_exp_f32 v157, v157
v_add_f32 v10, v10, v154
v_add_f32 v11, v11, v155
v_cvt_pk_bf16_f32 v205, v154, v155
v_sub_f32 v158, v158, v13
v_sub_f32 v159, v159, v13
v_exp_f32 v158, v158
s_waitcnt lgkmcnt(9)
v_mfma_f32_32x32x16_bf16 v[176:191], v[232:235], v[56:59], v[176:191]
ds_read_b64_tr_b16 v[224:225], v20 offset:1024
ds_read_b64_tr_b16 v[226:227], v20 offset:9216
v_exp_f32 v159, v159
v_add_f32 v10, v10, v156
v_add_f32 v11, v11, v157
v_cvt_pk_bf16_f32 v206, v156, v157
v_add_f32 v10, v10, v158
v_add_f32 v11, v11, v159
v_cvt_pk_bf16_f32 v207, v158, v159
s_waitcnt lgkmcnt(10)
v_mfma_f32_32x32x16_bf16 v[176:191], v[236:239], v[60:63], v[176:191]
ds_read_b64_tr_b16 v[228:229], v21 offset:1024
ds_read_b64_tr_b16 v[230:231], v21 offset:9216
s_waitcnt lgkmcnt(10)
v_mfma_f32_32x32x16_bf16 v[64:79], v[208:211], v[192:195], 0
ds_read_b64_tr_b16 v[232:233], v22 offset:1024
ds_read_b64_tr_b16 v[234:235], v22 offset:9216
v_max3_f32 v13, v160, v161, v162
v_max3_f32 v13, v163, v164, v13
v_max3_f32 v13, v165, v166, v13
v_max3_f32 v13, v167, v168, v13
s_waitcnt lgkmcnt(10)
v_mfma_f32_32x32x16_bf16 v[80:95], v[212:215], v[192:195], 0
ds_read_b64_tr_b16 v[236:237], v23 offset:1024
ds_read_b64_tr_b16 v[238:239], v23 offset:9216
s_add_u32 m0, s65, 65536
s_add_u32 s59, s58, 49152
buffer_load_dwordx4 v2, s[36:39], s59 offen offset:2048 nt lds
v_max3_f32 v13, v169, v170, v13
v_max3_f32 v13, v171, v172, v13
v_max3_f32 v13, v173, v174, v13
s_waitcnt lgkmcnt(10)
v_mfma_f32_32x32x16_bf16 v[96:111], v[216:219], v[192:195], 0
ds_read_b64_tr_b16 v[208:209], v20 offset:2048
ds_read_b64_tr_b16 v[210:211], v20 offset:10240
v_max3_f32 v14, v176, v177, v175
v_max3_f32 v14, v178, v179, v14
v_max3_f32 v14, v180, v181, v14
s_waitcnt lgkmcnt(10)
v_mfma_f32_32x32x16_bf16 v[112:127], v[220:223], v[192:195], 0
ds_read_b64_tr_b16 v[212:213], v21 offset:2048
ds_read_b64_tr_b16 v[214:215], v21 offset:10240
v_max3_f32 v14, v182, v183, v14
v_max3_f32 v14, v184, v185, v14
v_max3_f32 v14, v186, v187, v14
v_max3_f32 v14, v188, v189, v14
s_waitcnt lgkmcnt(10)
v_mfma_f32_32x32x16_bf16 v[64:79], v[224:227], v[196:199], v[64:79]
ds_read_b64_tr_b16 v[216:217], v22 offset:2048
ds_read_b64_tr_b16 v[218:219], v22 offset:10240
v_max3_f32 v14, v190, v191, v14
v_max_f32 v13, v13, v14
v_cmp_lt_f32 vcc, 0x41000000, v13
s_nop 0
s_cbranch_vccz L1_ok1
v_mov_b32 v14, v13
s_nop 1
v_permlane32_swap_b32 v13, v14
s_nop 1
v_max_f32 v13, v13, v14
v_cmp_lt_f32 vcc, 0x41000000, v13
s_nop 1
v_cndmask_b32 v13, 0, v13, vcc
v_exp_f32 v12, -v13
v_sub_f32 v160, v160, v13
v_sub_f32 v161, v161, v13
v_sub_f32 v162, v162, v13
v_sub_f32 v163, v163, v13
v_sub_f32 v164, v164, v13
v_sub_f32 v165, v165, v13
v_sub_f32 v166, v166, v13
v_sub_f32 v167, v167, v13
v_sub_f32 v168, v168, v13
v_sub_f32 v169, v169, v13
v_sub_f32 v170, v170, v13
v_sub_f32 v171, v171, v13
v_sub_f32 v172, v172, v13
v_sub_f32 v173, v173, v13
v_sub_f32 v174, v174, v13
v_sub_f32 v175, v175, v13
v_sub_f32 v176, v176, v13
v_sub_f32 v177, v177, v13
v_sub_f32 v178, v178, v13
v_sub_f32 v179, v179, v13
v_sub_f32 v180, v180, v13
v_sub_f32 v181, v181, v13
v_sub_f32 v182, v182, v13
v_sub_f32 v183, v183, v13
v_sub_f32 v184, v184, v13
v_sub_f32 v185, v185, v13
v_sub_f32 v186, v186, v13
v_sub_f32 v187, v187, v13
v_sub_f32 v188, v188, v13
v_sub_f32 v189, v189, v13
v_sub_f32 v190, v190, v13
v_sub_f32 v191, v191, v13
v_sub_f32 v240, v240, v13
v_sub_f32 v241, v241, v13
v_sub_f32 v242, v242, v13
v_sub_f32 v243, v243, v13
v_sub_f32 v244, v244, v13
v_sub_f32 v245, v245, v13
v_sub_f32 v246, v246, v13
v_sub_f32 v247, v247, v13
v_sub_f32 v248, v248, v13
v_sub_f32 v249, v249, v13
v_sub_f32 v250, v250, v13
v_sub_f32 v251, v251, v13
v_sub_f32 v252, v252, v13
v_sub_f32 v253, v253, v13
v_sub_f32 v254, v254, v13
v_sub_f32 v255, v255, v13
v_mul_f32 v10, v12, v10
v_mul_f32 v11, v12, v11
L1_ok1:
s_waitcnt lgkmcnt(10)
v_mfma_f32_32x32x16_bf16 v[80:95], v[228:231], v[196:199], v[80:95]
ds_read_b64_tr_b16 v[220:221], v23 offset:2048
ds_read_b64_tr_b16 v[222:223], v23 offset:10240
s_add_u32 m0, s65, 65536
s_add_u32 s59, s58, 49152
buffer_load_dwordx4 v2, s[36:39], s59 offen offset:3072 nt lds
v_exp_f32 v160, v160
v_exp_f32 v161, v161
s_waitcnt lgkmcnt(10)
v_mfma_f32_32x32x16_bf16 v[96:111], v[232:235], v[196:199], v[96:111]
ds_read_b64_tr_b16 v[224:225], v20 offset:3072
ds_read_b64_tr_b16 v[226:227], v20 offset:11264
v_exp_f32 v162, v162
v_exp_f32 v163, v163
s_waitcnt lgkmcnt(10)
v_mfma_f32_32x32x16_bf16 v[112:127], v[236:239], v[196:199], v[112:127]
ds_read_b64_tr_b16 v[228:229], v21 offset:3072
ds_read_b64_tr_b16 v[230:231], v21 offset:11264
v_add_f32 v10, v10, v160
v_add_f32 v11, v11, v161
s_waitcnt lgkmcnt(10)
v_mfma_f32_32x32x16_bf16 v[64:79], v[208:211], v[200:203], v[64:79]
ds_read_b64_tr_b16 v[232:233], v22 offset:3072
ds_read_b64_tr_b16 v[234:235], v22 offset:11264
v_exp_f32 v164, v164
v_exp_f32 v165, v165
s_waitcnt lgkmcnt(10)
v_mfma_f32_32x32x16_bf16 v[80:95], v[212:215], v[200:203], v[80:95]
ds_read_b64_tr_b16 v[236:237], v23 offset:3072
ds_read_b64_tr_b16 v[238:239], v23 offset:11264
v_add_u32 v24, 0, v6
v_xor_b32 v25, 32, v24
v_xor_b32 v26, 64, v24
v_xor_b32 v27, 96, v24
v_xor_b32 v28, 128, v24
v_xor_b32 v29, 160, v24
v_xor_b32 v30, 192, v24
v_xor_b32 v31, 224, v24
s_waitcnt vmcnt(8)
s_barrier
s_add_u32 m0, s65, 98304
s_add_u32 s59, s58, 32768
buffer_load_dwordx4 v3, s[40:43], s59 offen offset:0 nt lds
v_add_f32 v10, v10, v162
v_add_f32 v11, v11, v163
v_exp_f32 v166, v166
s_waitcnt lgkmcnt(10)
v_mfma_f32_32x32x16_bf16 v[96:111], v[216:219], v[200:203], v[96:111]
ds_read_b128 v[208:211], v24 offset:0
v_exp_f32 v167, v167
s_waitcnt lgkmcnt(9)
v_mfma_f32_32x32x16_bf16 v[112:127], v[220:223], v[200:203], v[112:127]
ds_read_b128 v[212:215], v25 offset:0
v_add_f32 v10, v10, v164
v_add_f32 v11, v11, v165
v_exp_f32 v168, v168
s_waitcnt lgkmcnt(8)
v_mfma_f32_32x32x16_bf16 v[64:79], v[224:227], v[204:207], v[64:79]
ds_read_b128 v[216:219], v26 offset:0
v_exp_f32 v169, v169
v_add_f32 v10, v10, v166
s_waitcnt lgkmcnt(7)
v_mfma_f32_32x32x16_bf16 v[80:95], v[228:231], v[204:207], v[80:95]
ds_read_b128 v[220:223], v27 offset:0
s_add_u32 m0, s65, 98304
s_add_u32 s59, s58, 32768
buffer_load_dwordx4 v3, s[40:43], s59 offen offset:1024 nt lds
v_add_f32 v11, v11, v167
v_exp_f32 v170, v170
s_waitcnt lgkmcnt(6)
v_mfma_f32_32x32x16_bf16 v[96:111], v[232:235], v[204:207], v[96:111]
ds_read_b128 v[224:227], v28 offset:0
v_exp_f32 v171, v171
v_add_f32 v10, v10, v168
s_waitcnt lgkmcnt(5)
v_mfma_f32_32x32x16_bf16 v[112:127], v[236:239], v[204:207], v[112:127]
ds_read_b128 v[228:231], v29 offset:0
v_add_f32 v11, v11, v169
v_add_f32 v10, v10, v170
v_add_f32 v11, v11, v171
s_cbranch_vccz L1_nr0
s_nop 7
s_nop 3
v_mul_f32 v64, v12, v64
v_mul_f32 v65, v12, v65
v_mul_f32 v66, v12, v66
v_mul_f32 v67, v12, v67
v_mul_f32 v68, v12, v68
v_mul_f32 v69, v12, v69
v_mul_f32 v70, v12, v70
v_mul_f32 v71, v12, v71
v_mul_f32 v72, v12, v72
v_mul_f32 v73, v12, v73
v_mul_f32 v74, v12, v74
v_mul_f32 v75, v12, v75
v_mul_f32 v76, v12, v76
v_mul_f32 v77, v12, v77
v_mul_f32 v78, v12, v78
v_mul_f32 v79, v12, v79
v_mul_f32 v80, v12, v80
v_mul_f32 v81, v12, v81
v_mul_f32 v82, v12, v82
v_mul_f32 v83, v12, v83
v_mul_f32 v84, v12, v84
v_mul_f32 v85, v12, v85
v_mul_f32 v86, v12, v86
v_mul_f32 v87, v12, v87
v_mul_f32 v88, v12, v88
v_mul_f32 v89, v12, v89
v_mul_f32 v90, v12, v90
v_mul_f32 v91, v12, v91
v_mul_f32 v92, v12, v92
v_mul_f32 v93, v12, v93
v_mul_f32 v94, v12, v94
v_mul_f32 v95, v12, v95
v_mul_f32 v96, v12, v96
v_mul_f32 v97, v12, v97
v_mul_f32 v98, v12, v98
v_mul_f32 v99, v12, v99
v_mul_f32 v100, v12, v100
v_mul_f32 v101, v12, v101
v_mul_f32 v102, v12, v102
v_mul_f32 v103, v12, v103
v_mul_f32 v104, v12, v104
v_mul_f32 v105, v12, v105
v_mul_f32 v106, v12, v106
v_mul_f32 v107, v12, v107
v_mul_f32 v108, v12, v108
v_mul_f32 v109, v12, v109
v_mul_f32 v110, v12, v110
v_mul_f32 v111, v12, v111
v_mul_f32 v112, v12, v112
v_mul_f32 v113, v12, v113
v_mul_f32 v114, v12, v114
v_mul_f32 v115, v12, v115
v_mul_f32 v116, v12, v116
v_mul_f32 v117, v12, v117
v_mul_f32 v118, v12, v118
v_mul_f32 v119, v12, v119
v_mul_f32 v120, v12, v120
v_mul_f32 v121, v12, v121
v_mul_f32 v122, v12, v122
v_mul_f32 v123, v12, v123
v_mul_f32 v124, v12, v124
v_mul_f32 v125, v12, v125
v_mul_f32 v126, v12, v126
v_mul_f32 v127, v12, v127
L1_nr0:
s_waitcnt lgkmcnt(5)
v_mfma_f32_32x32x16_bf16 v[128:143], v[208:211], v[32:35], v[240:255]
ds_read_b128 v[232:235], v30 offset:0
v_exp_f32 v172, v172
v_exp_f32 v173, v173
v_cvt_pk_bf16_f32 v192, v160, v161
v_exp_f32 v174, v174
s_waitcnt lgkmcnt(5)
v_mfma_f32_32x32x16_bf16 v[128:143], v[212:215], v[36:39], v[128:143]
ds_read_b128 v[236:239], v31 offset:0
s_add_u32 m0, s65, 98304
s_add_u32 s59, s58, 32768
buffer_load_dwordx4 v3, s[40:43], s59 offen offset:2048 nt lds
v_exp_f32 v175, v175
v_cvt_pk_bf16_f32 v193, v162, v163
v_add_f32 v10, v10, v172
s_waitcnt lgkmcnt(5)
v_mfma_f32_32x32x16_bf16 v[128:143], v[216:219], v[40:43], v[128:143]
ds_read_b128 v[208:211], v24 offset:2048
v_add_f32 v11, v11, v173
v_cvt_pk_bf16_f32 v198, v172, v173
v_exp_f32 v176, v176
v_exp_f32 v177, v177
s_waitcnt lgkmcnt(5)
v_mfma_f32_32x32x16_bf16 v[128:143], v[220:223], v[44:47], v[128:143]
ds_read_b128 v[212:215], v25 offset:2048
v_cvt_pk_bf16_f32 v194, v164, v165
v_add_f32 v10, v10, v174
v_add_f32 v11, v11, v175
v_cvt_pk_bf16_f32 v199, v174, v175
s_waitcnt lgkmcnt(5)
v_mfma_f32_32x32x16_bf16 v[128:143], v[224:227], v[48:51], v[128:143]
ds_read_b128 v[216:219], v26 offset:2048
v_exp_f32 v178, v178
v_exp_f32 v179, v179
v_cvt_pk_bf16_f32 v195, v166, v167
s_waitcnt lgkmcnt(5)
v_mfma_f32_32x32x16_bf16 v[128:143], v[228:231], v[52:55], v[128:143]
ds_read_b128 v[220:223], v27 offset:2048
s_add_u32 m0, s65, 98304
s_add_u32 s59, s58, 32768
buffer_load_dwordx4 v3, s[40:43], s59 offen offset:3072 nt lds
v_add_f32 v10, v10, v176
v_add_f32 v11, v11, v177
v_cvt_pk_bf16_f32 v200, v176, v177
v_exp_f32 v180, v180
s_waitcnt lgkmcnt(5)
v_mfma_f32_32x32x16_bf16 v[128:143], v[232:235], v[56:59], v[128:143]
ds_read_b128 v[224:227], v28 offset:2048
v_exp_f32 v181, v181
v_cvt_pk_bf16_f32 v196, v168, v169
v_add_f32 v10, v10, v178
v_add_f32 v11, v11, v179
s_waitcnt lgkmcnt(5)
v_mfma_f32_32x32x16_bf16 v[128:143], v[236:239], v[60:63], v[128:143]
ds_read_b128 v[228:231], v29 offset:2048
v_cvt_pk_bf16_f32 v201, v178, v179
v_exp_f32 v182, v182
v_exp_f32 v183, v183
s_waitcnt lgkmcnt(5)
v_mfma_f32_32x32x16_bf16 v[144:159], v[208:211], v[32:35], v[240:255]
ds_read_b128 v[232:235], v30 offset:2048
v_cvt_pk_bf16_f32 v197, v170, v171
v_add_f32 v10, v10, v180
v_add_f32 v11, v11, v181
v_cvt_pk_bf16_f32 v202, v180, v181
v_exp_f32 v184, v184
s_waitcnt lgkmcnt(5)
v_mfma_f32_32x32x16_bf16 v[144:159], v[212:215], v[36:39], v[144:159]
ds_read_b128 v[236:239], v31 offset:2048
v_add_u32 v20, 0, v7
v_xor_b32 v21, 64, v20
v_xor_b32 v22, 128, v20
v_xor_b32 v23, 192, v20
s_waitcnt vmcnt(8)
s_barrier
s_add_u32 m0, s65, 131072
s_add_u32 s59, s58, 65536
buffer_load_dwordx4 v2, s[36:39], s59 offen offset:0 nt lds
v_exp_f32 v185, v185
v_add_f32 v10, v10, v182
v_add_f32 v11, v11, v183
s_waitcnt lgkmcnt(5)
v_mfma_f32_32x32x16_bf16 v[144:159], v[216:219], v[40:43], v[144:159]
ds_read_b64_tr_b16 v[208:209], v20 offset:32768
ds_read_b64_tr_b16 v[210:211], v20 offset:40960
v_cvt_pk_bf16_f32 v203, v182, v183
v_exp_f32 v186, v186
v_exp_f32 v187, v187
s_waitcnt lgkmcnt(6)
v_mfma_f32_32x32x16_bf16 v[144:159], v[220:223], v[44:47], v[144:159]
ds_read_b64_tr_b16 v[212:213], v21 offset:32768
ds_read_b64_tr_b16 v[214:215], v21 offset:40960
v_add_f32 v10, v10, v184
v_add_f32 v11, v11, v185
v_cvt_pk_bf16_f32 v204, v184, v185
v_exp_f32 v188, v188
s_waitcnt lgkmcnt(7)
v_mfma_f32_32x32x16_bf16 v[144:159], v[224:227], v[48:51], v[144:159]
ds_read_b64_tr_b16 v[216:217], v22 offset:32768
ds_read_b64_tr_b16 v[218:219], v22 offset:40960
v_exp_f32 v189, v189
v_add_f32 v10, v10, v186
v_add_f32 v11, v11, v187
v_cvt_pk_bf16_f32 v205, v186, v187
s_waitcnt lgkmcnt(8)
v_mfma_f32_32x32x16_bf16 v[144:159], v[228:231], v[52:55], v[144:159]
ds_read_b64_tr_b16 v[220:221], v23 offset:32768
ds_read_b64_tr_b16 v[222:223], v23 offset:40960
s_add_u32 m0, s65, 131072
s_add_u32 s59, s58, 65536
buffer_load_dwordx4 v2, s[36:39], s59 offen offset:1024 nt lds
v_exp_f32 v190, v190
v_exp_f32 v191, v191
v_add_f32 v10, v10, v188
s_waitcnt lgkmcnt(9)
v_mfma_f32_32x32x16_bf16 v[144:159], v[232:235], v[56:59], v[144:159]
ds_read_b64_tr_b16 v[224:225], v20 offset:33792
ds_read_b64_tr_b16 v[226:227], v20 offset:41984
v_add_f32 v11, v11, v189
v_cvt_pk_bf16_f32 v206, v188, v189
v_add_f32 v10, v10, v190
v_add_f32 v11, v11, v191
v_cvt_pk_bf16_f32 v207, v190, v191
s_waitcnt lgkmcnt(10)
v_mfma_f32_32x32x16_bf16 v[144:159], v[236:239], v[60:63], v[144:159]
ds_read_b64_tr_b16 v[228:229], v21 offset:33792
ds_read_b64_tr_b16 v[230:231], v21 offset:41984
s_waitcnt lgkmcnt(10)
v_mfma_f32_32x32x16_bf16 v[64:79], v[208:211], v[192:195], v[64:79]
ds_read_b64_tr_b16 v[232:233], v22 offset:33792
ds_read_b64_tr_b16 v[234:235], v22 offset:41984
v_max3_f32 v13, v128, v129, v130
v_max3_f32 v13, v131, v132, v13
v_max3_f32 v13, v133, v134, v13
v_max3_f32 v13, v135, v136, v13
s_waitcnt lgkmcnt(10)
v_mfma_f32_32x32x16_bf16 v[80:95], v[212:215], v[192:195], v[80:95]
ds_read_b64_tr_b16 v[236:237], v23 offset:33792
ds_read_b64_tr_b16 v[238:239], v23 offset:41984
s_add_u32 m0, s65, 131072
s_add_u32 s59, s58, 65536
buffer_load_dwordx4 v2, s[36:39], s59 offen offset:2048 nt lds
v_max3_f32 v13, v137, v138, v13
v_max3_f32 v13, v139, v140, v13
v_max3_f32 v13, v141, v142, v13
s_waitcnt lgkmcnt(10)
v_mfma_f32_32x32x16_bf16 v[96:111], v[216:219], v[192:195], v[96:111]
ds_read_b64_tr_b16 v[208:209], v20 offset:34816
ds_read_b64_tr_b16 v[210:211], v20 offset:43008
v_max3_f32 v14, v144, v145, v143
v_max3_f32 v14, v146, v147, v14
v_max3_f32 v14, v148, v149, v14
s_waitcnt lgkmcnt(10)
v_mfma_f32_32x32x16_bf16 v[112:127], v[220:223], v[192:195], v[112:127]
ds_read_b64_tr_b16 v[212:213], v21 offset:34816
ds_read_b64_tr_b16 v[214:215], v21 offset:43008
v_max3_f32 v14, v150, v151, v14
v_max3_f32 v14, v152, v153, v14
v_max3_f32 v14, v154, v155, v14
v_max3_f32 v14, v156, v157, v14
s_waitcnt lgkmcnt(10)
v_mfma_f32_32x32x16_bf16 v[64:79], v[224:227], v[196:199], v[64:79]
ds_read_b64_tr_b16 v[216:217], v22 offset:34816
ds_read_b64_tr_b16 v[218:219], v22 offset:43008
v_max3_f32 v14, v158, v159, v14
v_max_f32 v13, v13, v14
v_cmp_lt_f32 vcc, 0x41000000, v13
s_nop 0
s_cbranch_vccz L1_ok2
v_mov_b32 v14, v13
s_nop 1
v_permlane32_swap_b32 v13, v14
s_nop 1
v_max_f32 v13, v13, v14
v_cmp_lt_f32 vcc, 0x41000000, v13
s_nop 1
v_cndmask_b32 v13, 0, v13, vcc
v_exp_f32 v12, -v13
v_sub_f32 v128, v128, v13
v_sub_f32 v129, v129, v13
v_sub_f32 v130, v130, v13
v_sub_f32 v131, v131, v13
v_sub_f32 v132, v132, v13
v_sub_f32 v133, v133, v13
v_sub_f32 v134, v134, v13
v_sub_f32 v135, v135, v13
v_sub_f32 v136, v136, v13
v_sub_f32 v137, v137, v13
v_sub_f32 v138, v138, v13
v_sub_f32 v139, v139, v13
v_sub_f32 v140, v140, v13
v_sub_f32 v141, v141, v13
v_sub_f32 v142, v142, v13
v_sub_f32 v143, v143, v13
v_sub_f32 v144, v144, v13
v_sub_f32 v145, v145, v13
v_sub_f32 v146, v146, v13
v_sub_f32 v147, v147, v13
v_sub_f32 v148, v148, v13
v_sub_f32 v149, v149, v13
v_sub_f32 v150, v150, v13
v_sub_f32 v151, v151, v13
v_sub_f32 v152, v152, v13
v_sub_f32 v153, v153, v13
v_sub_f32 v154, v154, v13
v_sub_f32 v155, v155, v13
v_sub_f32 v156, v156, v13
v_sub_f32 v157, v157, v13
v_sub_f32 v158, v158, v13
v_sub_f32 v159, v159, v13
v_sub_f32 v240, v240, v13
v_sub_f32 v241, v241, v13
v_sub_f32 v242, v242, v13
v_sub_f32 v243, v243, v13
v_sub_f32 v244, v244, v13
v_sub_f32 v245, v245, v13
v_sub_f32 v246, v246, v13
v_sub_f32 v247, v247, v13
v_sub_f32 v248, v248, v13
v_sub_f32 v249, v249, v13
v_sub_f32 v250, v250, v13
v_sub_f32 v251, v251, v13
v_sub_f32 v252, v252, v13
v_sub_f32 v253, v253, v13
v_sub_f32 v254, v254, v13
v_sub_f32 v255, v255, v13
v_mul_f32 v10, v12, v10
v_mul_f32 v11, v12, v11
L1_ok2:
s_waitcnt lgkmcnt(10)
v_mfma_f32_32x32x16_bf16 v[80:95], v[228:231], v[196:199], v[80:95]
ds_read_b64_tr_b16 v[220:221], v23 offset:34816
ds_read_b64_tr_b16 v[222:223], v23 offset:43008
s_add_u32 m0, s65, 131072
s_add_u32 s59, s58, 65536
buffer_load_dwordx4 v2, s[36:39], s59 offen offset:3072 nt lds
v_exp_f32 v128, v128
v_exp_f32 v129, v129
s_waitcnt lgkmcnt(10)
v_mfma_f32_32x32x16_bf16 v[96:111], v[232:235], v[196:199], v[96:111]
ds_read_b64_tr_b16 v[224:225], v20 offset:35840
ds_read_b64_tr_b16 v[226:227], v20 offset:44032
v_exp_f32 v130, v130
v_exp_f32 v131, v131
s_waitcnt lgkmcnt(10)
v_mfma_f32_32x32x16_bf16 v[112:127], v[236:239], v[196:199], v[112:127]
ds_read_b64_tr_b16 v[228:229], v21 offset:35840
ds_read_b64_tr_b16 v[230:231], v21 offset:44032
v_add_f32 v10, v10, v128
v_add_f32 v11, v11, v129
s_waitcnt lgkmcnt(10)
v_mfma_f32_32x32x16_bf16 v[64:79], v[208:211], v[200:203], v[64:79]
ds_read_b64_tr_b16 v[232:233], v22 offset:35840
ds_read_b64_tr_b16 v[234:235], v22 offset:44032
v_exp_f32 v132, v132
v_exp_f32 v133, v133
s_waitcnt lgkmcnt(10)
v_mfma_f32_32x32x16_bf16 v[80:95], v[212:215], v[200:203], v[80:95]
ds_read_b64_tr_b16 v[236:237], v23 offset:35840
ds_read_b64_tr_b16 v[238:239], v23 offset:44032
v_add_u32 v24, 65536, v6
v_xor_b32 v25, 32, v24
v_xor_b32 v26, 64, v24
v_xor_b32 v27, 96, v24
v_xor_b32 v28, 128, v24
v_xor_b32 v29, 160, v24
v_xor_b32 v30, 192, v24
v_xor_b32 v31, 224, v24
s_waitcnt vmcnt(8)
s_barrier
s_add_u32 m0, s65, 0
s_add_u32 s59, s58, 49152
buffer_load_dwordx4 v3, s[40:43], s59 offen offset:0 nt lds
v_add_f32 v10, v10, v130
v_add_f32 v11, v11, v131
v_exp_f32 v134, v134
s_waitcnt lgkmcnt(10)
v_mfma_f32_32x32x16_bf16 v[96:111], v[216:219], v[200:203], v[96:111]
ds_read_b128 v[208:211], v24 offset:0
v_exp_f32 v135, v135
s_waitcnt lgkmcnt(9)
v_mfma_f32_32x32x16_bf16 v[112:127], v[220:223], v[200:203], v[112:127]
ds_read_b128 v[212:215], v25 offset:0
v_add_f32 v10, v10, v132
v_add_f32 v11, v11, v133
v_exp_f32 v136, v136
s_waitcnt lgkmcnt(8)
v_mfma_f32_32x32x16_bf16 v[64:79], v[224:227], v[204:207], v[64:79]
ds_read_b128 v[216:219], v26 offset:0
v_exp_f32 v137, v137
v_add_f32 v10, v10, v134
s_waitcnt lgkmcnt(7)
v_mfma_f32_32x32x16_bf16 v[80:95], v[228:231], v[204:207], v[80:95]
ds_read_b128 v[220:223], v27 offset:0
s_add_u32 m0, s65, 0
s_add_u32 s59, s58, 49152
buffer_load_dwordx4 v3, s[40:43], s59 offen offset:1024 nt lds
v_add_f32 v11, v11, v135
v_exp_f32 v138, v138
s_waitcnt lgkmcnt(6)
v_mfma_f32_32x32x16_bf16 v[96:111], v[232:235], v[204:207], v[96:111]
ds_read_b128 v[224:227], v28 offset:0
v_exp_f32 v139, v139
v_add_f32 v10, v10, v136
s_waitcnt lgkmcnt(5)
v_mfma_f32_32x32x16_bf16 v[112:127], v[236:239], v[204:207], v[112:127]
ds_read_b128 v[228:231], v29 offset:0
v_add_f32 v11, v11, v137
v_add_f32 v10, v10, v138
v_add_f32 v11, v11, v139
s_cbranch_vccz L1_nr1
s_nop 7
s_nop 3
v_mul_f32 v64, v12, v64
v_mul_f32 v65, v12, v65
v_mul_f32 v66, v12, v66
v_mul_f32 v67, v12, v67
v_mul_f32 v68, v12, v68
v_mul_f32 v69, v12, v69
v_mul_f32 v70, v12, v70
v_mul_f32 v71, v12, v71
v_mul_f32 v72, v12, v72
v_mul_f32 v73, v12, v73
v_mul_f32 v74, v12, v74
v_mul_f32 v75, v12, v75
v_mul_f32 v76, v12, v76
v_mul_f32 v77, v12, v77
v_mul_f32 v78, v12, v78
v_mul_f32 v79, v12, v79
v_mul_f32 v80, v12, v80
v_mul_f32 v81, v12, v81
v_mul_f32 v82, v12, v82
v_mul_f32 v83, v12, v83
v_mul_f32 v84, v12, v84
v_mul_f32 v85, v12, v85
v_mul_f32 v86, v12, v86
v_mul_f32 v87, v12, v87
v_mul_f32 v88, v12, v88
v_mul_f32 v89, v12, v89
v_mul_f32 v90, v12, v90
v_mul_f32 v91, v12, v91
v_mul_f32 v92, v12, v92
v_mul_f32 v93, v12, v93
v_mul_f32 v94, v12, v94
v_mul_f32 v95, v12, v95
v_mul_f32 v96, v12, v96
v_mul_f32 v97, v12, v97
v_mul_f32 v98, v12, v98
v_mul_f32 v99, v12, v99
v_mul_f32 v100, v12, v100
v_mul_f32 v101, v12, v101
v_mul_f32 v102, v12, v102
v_mul_f32 v103, v12, v103
v_mul_f32 v104, v12, v104
v_mul_f32 v105, v12, v105
v_mul_f32 v106, v12, v106
v_mul_f32 v107, v12, v107
v_mul_f32 v108, v12, v108
v_mul_f32 v109, v12, v109
v_mul_f32 v110, v12, v110
v_mul_f32 v111, v12, v111
v_mul_f32 v112, v12, v112
v_mul_f32 v113, v12, v113
v_mul_f32 v114, v12, v114
v_mul_f32 v115, v12, v115
v_mul_f32 v116, v12, v116
v_mul_f32 v117, v12, v117
v_mul_f32 v118, v12, v118
v_mul_f32 v119, v12, v119
v_mul_f32 v120, v12, v120
v_mul_f32 v121, v12, v121
v_mul_f32 v122, v12, v122
v_mul_f32 v123, v12, v123
v_mul_f32 v124, v12, v124
v_mul_f32 v125, v12, v125
v_mul_f32 v126, v12, v126
v_mul_f32 v127, v12, v127
L1_nr1:
s_waitcnt lgkmcnt(5)
v_mfma_f32_32x32x16_bf16 v[160:175], v[208:211], v[32:35], v[240:255]
ds_read_b128 v[232:235], v30 offset:0
v_exp_f32 v140, v140
v_exp_f32 v141, v141
v_cvt_pk_bf16_f32 v192, v128, v129
v_exp_f32 v142, v142
s_waitcnt lgkmcnt(5)
v_mfma_f32_32x32x16_bf16 v[160:175], v[212:215], v[36:39], v[160:175]
ds_read_b128 v[236:239], v31 offset:0
s_add_u32 m0, s65, 0
s_add_u32 s59, s58, 49152
buffer_load_dwordx4 v3, s[40:43], s59 offen offset:2048 nt lds
v_exp_f32 v143, v143
v_cvt_pk_bf16_f32 v193, v130, v131
v_add_f32 v10, v10, v140
s_waitcnt lgkmcnt(5)
v_mfma_f32_32x32x16_bf16 v[160:175], v[216:219], v[40:43], v[160:175]
ds_read_b128 v[208:211], v24 offset:2048
v_add_f32 v11, v11, v141
v_cvt_pk_bf16_f32 v198, v140, v141
v_exp_f32 v144, v144
v_exp_f32 v145, v145
s_waitcnt lgkmcnt(5)
v_mfma_f32_32x32x16_bf16 v[160:175], v[220:223], v[44:47], v[160:175]
ds_read_b128 v[212:215], v25 offset:2048
v_cvt_pk_bf16_f32 v194, v132, v133
v_add_f32 v10, v10, v142
v_add_f32 v11, v11, v143
v_cvt_pk_bf16_f32 v199, v142, v143
s_waitcnt lgkmcnt(5)
v_mfma_f32_32x32x16_bf16 v[160:175], v[224:227], v[48:51], v[160:175]
ds_read_b128 v[216:219], v26 offset:2048
v_exp_f32 v146, v146
v_exp_f32 v147, v147
v_cvt_pk_bf16_f32 v195, v134, v135
s_waitcnt lgkmcnt(5)
v_mfma_f32_32x32x16_bf16 v[160:175], v[228:231], v[52:55], v[160:175]
ds_read_b128 v[220:223], v27 offset:2048
s_add_u32 m0, s65, 0
s_add_u32 s59, s58, 49152
buffer_load_dwordx4 v3, s[40:43], s59 offen offset:3072 nt lds
v_add_f32 v10, v10, v144
v_add_f32 v11, v11, v145
v_cvt_pk_bf16_f32 v200, v144, v145
v_exp_f32 v148, v148
s_waitcnt lgkmcnt(5)
v_mfma_f32_32x32x16_bf16 v[160:175], v[232:235], v[56:59], v[160:175]
ds_read_b128 v[224:227], v28 offset:2048
v_exp_f32 v149, v149
v_cvt_pk_bf16_f32 v196, v136, v137
v_add_f32 v10, v10, v146
v_add_f32 v11, v11, v147
s_waitcnt lgkmcnt(5)
v_mfma_f32_32x32x16_bf16 v[160:175], v[236:239], v[60:63], v[160:175]
ds_read_b128 v[228:231], v29 offset:2048
v_cvt_pk_bf16_f32 v201, v146, v147
v_exp_f32 v150, v150
v_exp_f32 v151, v151
s_waitcnt lgkmcnt(5)
v_mfma_f32_32x32x16_bf16 v[176:191], v[208:211], v[32:35], v[240:255]
ds_read_b128 v[232:235], v30 offset:2048
v_cvt_pk_bf16_f32 v197, v138, v139
v_add_f32 v10, v10, v148
v_add_f32 v11, v11, v149
v_cvt_pk_bf16_f32 v202, v148, v149
v_exp_f32 v152, v152
s_waitcnt lgkmcnt(5)
v_mfma_f32_32x32x16_bf16 v[176:191], v[212:215], v[36:39], v[176:191]
ds_read_b128 v[236:239], v31 offset:2048
v_add_u32 v20, 65536, v7
v_xor_b32 v21, 64, v20
v_xor_b32 v22, 128, v20
v_xor_b32 v23, 192, v20
s_waitcnt vmcnt(8)
s_barrier
s_add_u32 m0, s65, 32768
s_add_u32 s59, s58, 81920
buffer_load_dwordx4 v2, s[36:39], s59 offen offset:0 nt lds
v_exp_f32 v153, v153
v_add_f32 v10, v10, v150
v_add_f32 v11, v11, v151
s_waitcnt lgkmcnt(5)
v_mfma_f32_32x32x16_bf16 v[176:191], v[216:219], v[40:43], v[176:191]
ds_read_b64_tr_b16 v[208:209], v20 offset:32768
ds_read_b64_tr_b16 v[210:211], v20 offset:40960
v_cvt_pk_bf16_f32 v203, v150, v151
v_exp_f32 v154, v154
v_exp_f32 v155, v155
s_waitcnt lgkmcnt(6)
v_mfma_f32_32x32x16_bf16 v[176:191], v[220:223], v[44:47], v[176:191]
ds_read_b64_tr_b16 v[212:213], v21 offset:32768
ds_read_b64_tr_b16 v[214:215], v21 offset:40960
v_add_f32 v10, v10, v152
v_add_f32 v11, v11, v153
v_cvt_pk_bf16_f32 v204, v152, v153
v_exp_f32 v156, v156
s_waitcnt lgkmcnt(7)
v_mfma_f32_32x32x16_bf16 v[176:191], v[224:227], v[48:51], v[176:191]
ds_read_b64_tr_b16 v[216:217], v22 offset:32768
ds_read_b64_tr_b16 v[218:219], v22 offset:40960
v_exp_f32 v157, v157
v_add_f32 v10, v10, v154
v_add_f32 v11, v11, v155
v_cvt_pk_bf16_f32 v205, v154, v155
s_waitcnt lgkmcnt(8)
v_mfma_f32_32x32x16_bf16 v[176:191], v[228:231], v[52:55], v[176:191]
ds_read_b64_tr_b16 v[220:221], v23 offset:32768
ds_read_b64_tr_b16 v[222:223], v23 offset:40960
s_add_u32 m0, s65, 32768
s_add_u32 s59, s58, 81920
buffer_load_dwordx4 v2, s[36:39], s59 offen offset:1024 nt lds
v_exp_f32 v158, v158
v_exp_f32 v159, v159
v_add_f32 v10, v10, v156
s_waitcnt lgkmcnt(9)
v_mfma_f32_32x32x16_bf16 v[176:191], v[232:235], v[56:59], v[176:191]
ds_read_b64_tr_b16 v[224:225], v20 offset:33792
ds_read_b64_tr_b16 v[226:227], v20 offset:41984
v_add_f32 v11, v11, v157
v_cvt_pk_bf16_f32 v206, v156, v157
v_add_f32 v10, v10, v158
v_add_f32 v11, v11, v159
v_cvt_pk_bf16_f32 v207, v158, v159
s_waitcnt lgkmcnt(10)
v_mfma_f32_32x32x16_bf16 v[176:191], v[236:239], v[60:63], v[176:191]
ds_read_b64_tr_b16 v[228:229], v21 offset:33792
ds_read_b64_tr_b16 v[230:231], v21 offset:41984
s_waitcnt lgkmcnt(10)
v_mfma_f32_32x32x16_bf16 v[64:79], v[208:211], v[192:195], v[64:79]
ds_read_b64_tr_b16 v[232:233], v22 offset:33792
ds_read_b64_tr_b16 v[234:235], v22 offset:41984
v_max3_f32 v13, v160, v161, v162
v_max3_f32 v13, v163, v164, v13
v_max3_f32 v13, v165, v166, v13
v_max3_f32 v13, v167, v168, v13
s_waitcnt lgkmcnt(10)
v_mfma_f32_32x32x16_bf16 v[80:95], v[212:215], v[192:195], v[80:95]
ds_read_b64_tr_b16 v[236:237], v23 offset:33792
ds_read_b64_tr_b16 v[238:239], v23 offset:41984
s_add_u32 m0, s65, 32768
s_add_u32 s59, s58, 81920
buffer_load_dwordx4 v2, s[36:39], s59 offen offset:2048 nt lds
v_max3_f32 v13, v169, v170, v13
v_max3_f32 v13, v171, v172, v13
v_max3_f32 v13, v173, v174, v13
s_waitcnt lgkmcnt(10)
v_mfma_f32_32x32x16_bf16 v[96:111], v[216:219], v[192:195], v[96:111]
ds_read_b64_tr_b16 v[208:209], v20 offset:34816
ds_read_b64_tr_b16 v[210:211], v20 offset:43008
v_max3_f32 v14, v176, v177, v175
v_max3_f32 v14, v178, v179, v14
v_max3_f32 v14, v180, v181, v14
s_waitcnt lgkmcnt(10)
v_mfma_f32_32x32x16_bf16 v[112:127], v[220:223], v[192:195], v[112:127]
ds_read_b64_tr_b16 v[212:213], v21 offset:34816
ds_read_b64_tr_b16 v[214:215], v21 offset:43008
v_max3_f32 v14, v182, v183, v14
v_max3_f32 v14, v184, v185, v14
v_max3_f32 v14, v186, v187, v14
v_max3_f32 v14, v188, v189, v14
s_waitcnt lgkmcnt(10)
v_mfma_f32_32x32x16_bf16 v[64:79], v[224:227], v[196:199], v[64:79]
ds_read_b64_tr_b16 v[216:217], v22 offset:34816
ds_read_b64_tr_b16 v[218:219], v22 offset:43008
v_max3_f32 v14, v190, v191, v14
v_max_f32 v13, v13, v14
v_cmp_lt_f32 vcc, 0x41000000, v13
s_nop 0
s_cbranch_vccz L1_ok3
v_mov_b32 v14, v13
s_nop 1
v_permlane32_swap_b32 v13, v14
s_nop 1
v_max_f32 v13, v13, v14
v_cmp_lt_f32 vcc, 0x41000000, v13
s_nop 1
v_cndmask_b32 v13, 0, v13, vcc
v_exp_f32 v12, -v13
v_sub_f32 v160, v160, v13
v_sub_f32 v161, v161, v13
v_sub_f32 v162, v162, v13
v_sub_f32 v163, v163, v13
v_sub_f32 v164, v164, v13
v_sub_f32 v165, v165, v13
v_sub_f32 v166, v166, v13
v_sub_f32 v167, v167, v13
v_sub_f32 v168, v168, v13
v_sub_f32 v169, v169, v13
v_sub_f32 v170, v170, v13
v_sub_f32 v171, v171, v13
v_sub_f32 v172, v172, v13
v_sub_f32 v173, v173, v13
v_sub_f32 v174, v174, v13
v_sub_f32 v175, v175, v13
v_sub_f32 v176, v176, v13
v_sub_f32 v177, v177, v13
v_sub_f32 v178, v178, v13
v_sub_f32 v179, v179, v13
v_sub_f32 v180, v180, v13
v_sub_f32 v181, v181, v13
v_sub_f32 v182, v182, v13
v_sub_f32 v183, v183, v13
v_sub_f32 v184, v184, v13
v_sub_f32 v185, v185, v13
v_sub_f32 v186, v186, v13
v_sub_f32 v187, v187, v13
v_sub_f32 v188, v188, v13
v_sub_f32 v189, v189, v13
v_sub_f32 v190, v190, v13
v_sub_f32 v191, v191, v13
v_sub_f32 v240, v240, v13
v_sub_f32 v241, v241, v13
v_sub_f32 v242, v242, v13
v_sub_f32 v243, v243, v13
v_sub_f32 v244, v244, v13
v_sub_f32 v245, v245, v13
v_sub_f32 v246, v246, v13
v_sub_f32 v247, v247, v13
v_sub_f32 v248, v248, v13
v_sub_f32 v249, v249, v13
v_sub_f32 v250, v250, v13
v_sub_f32 v251, v251, v13
v_sub_f32 v252, v252, v13
v_sub_f32 v253, v253, v13
v_sub_f32 v254, v254, v13
v_sub_f32 v255, v255, v13
v_mul_f32 v10, v12, v10
v_mul_f32 v11, v12, v11
L1_ok3:
s_waitcnt lgkmcnt(10)
v_mfma_f32_32x32x16_bf16 v[80:95], v[228:231], v[196:199], v[80:95]
ds_read_b64_tr_b16 v[220:221], v23 offset:34816
ds_read_b64_tr_b16 v[222:223], v23 offset:43008
s_add_u32 m0, s65, 32768
s_add_u32 s59, s58, 81920
buffer_load_dwordx4 v2, s[36:39], s59 offen offset:3072 nt lds
v_exp_f32 v160, v160
v_exp_f32 v161, v161
s_waitcnt lgkmcnt(10)
v_mfma_f32_32x32x16_bf16 v[96:111], v[232:235], v[196:199], v[96:111]
ds_read_b64_tr_b16 v[224:225], v20 offset:35840
ds_read_b64_tr_b16 v[226:227], v20 offset:44032
v_exp_f32 v162, v162
v_exp_f32 v163, v163
s_waitcnt lgkmcnt(10)
v_mfma_f32_32x32x16_bf16 v[112:127], v[236:239], v[196:199], v[112:127]
ds_read_b64_tr_b16 v[228:229], v21 offset:35840
ds_read_b64_tr_b16 v[230:231], v21 offset:44032
v_add_f32 v10, v10, v160
v_add_f32 v11, v11, v161
s_waitcnt lgkmcnt(10)
v_mfma_f32_32x32x16_bf16 v[64:79], v[208:211], v[200:203], v[64:79]
ds_read_b64_tr_b16 v[232:233], v22 offset:35840
ds_read_b64_tr_b16 v[234:235], v22 offset:44032
v_exp_f32 v164, v164
v_exp_f32 v165, v165
s_waitcnt lgkmcnt(10)
v_mfma_f32_32x32x16_bf16 v[80:95], v[212:215], v[200:203], v[80:95]
ds_read_b64_tr_b16 v[236:237], v23 offset:35840
ds_read_b64_tr_b16 v[238:239], v23 offset:44032
v_add_u32 v24, 131072, v6
v_xor_b32 v25, 32, v24
v_xor_b32 v26, 64, v24
v_xor_b32 v27, 96, v24
v_xor_b32 v28, 128, v24
v_xor_b32 v29, 160, v24
v_xor_b32 v30, 192, v24
v_xor_b32 v31, 224, v24
s_waitcnt vmcnt(8)
s_barrier
s_add_u32 m0, s65, 65536
s_add_u32 s59, s58, 65536
buffer_load_dwordx4 v3, s[40:43], s59 offen offset:0 nt lds
v_add_f32 v10, v10, v162
v_add_f32 v11, v11, v163
v_exp_f32 v166, v166
s_waitcnt lgkmcnt(10)
v_mfma_f32_32x32x16_bf16 v[96:111], v[216:219], v[200:203], v[96:111]
ds_read_b128 v[208:211], v24 offset:0
v_exp_f32 v167, v167
s_waitcnt lgkmcnt(9)
v_mfma_f32_32x32x16_bf16 v[112:127], v[220:223], v[200:203], v[112:127]
ds_read_b128 v[212:215], v25 offset:0
v_add_f32 v10, v10, v164
v_add_f32 v11, v11, v165
v_exp_f32 v168, v168
s_waitcnt lgkmcnt(8)
v_mfma_f32_32x32x16_bf16 v[64:79], v[224:227], v[204:207], v[64:79]
ds_read_b128 v[216:219], v26 offset:0
v_exp_f32 v169, v169
v_add_f32 v10, v10, v166
s_waitcnt lgkmcnt(7)
v_mfma_f32_32x32x16_bf16 v[80:95], v[228:231], v[204:207], v[80:95]
ds_read_b128 v[220:223], v27 offset:0
s_add_u32 m0, s65, 65536
s_add_u32 s59, s58, 65536
buffer_load_dwordx4 v3, s[40:43], s59 offen offset:1024 nt lds
v_add_f32 v11, v11, v167
v_exp_f32 v170, v170
s_waitcnt lgkmcnt(6)
v_mfma_f32_32x32x16_bf16 v[96:111], v[232:235], v[204:207], v[96:111]
ds_read_b128 v[224:227], v28 offset:0
v_exp_f32 v171, v171
v_add_f32 v10, v10, v168
s_waitcnt lgkmcnt(5)
v_mfma_f32_32x32x16_bf16 v[112:127], v[236:239], v[204:207], v[112:127]
ds_read_b128 v[228:231], v29 offset:0
v_add_f32 v11, v11, v169
v_add_f32 v10, v10, v170
v_add_f32 v11, v11, v171
s_cbranch_vccz L1_nr2
s_nop 7
s_nop 3
v_mul_f32 v64, v12, v64
v_mul_f32 v65, v12, v65
v_mul_f32 v66, v12, v66
v_mul_f32 v67, v12, v67
v_mul_f32 v68, v12, v68
v_mul_f32 v69, v12, v69
v_mul_f32 v70, v12, v70
v_mul_f32 v71, v12, v71
v_mul_f32 v72, v12, v72
v_mul_f32 v73, v12, v73
v_mul_f32 v74, v12, v74
v_mul_f32 v75, v12, v75
v_mul_f32 v76, v12, v76
v_mul_f32 v77, v12, v77
v_mul_f32 v78, v12, v78
v_mul_f32 v79, v12, v79
v_mul_f32 v80, v12, v80
v_mul_f32 v81, v12, v81
v_mul_f32 v82, v12, v82
v_mul_f32 v83, v12, v83
v_mul_f32 v84, v12, v84
v_mul_f32 v85, v12, v85
v_mul_f32 v86, v12, v86
v_mul_f32 v87, v12, v87
v_mul_f32 v88, v12, v88
v_mul_f32 v89, v12, v89
v_mul_f32 v90, v12, v90
v_mul_f32 v91, v12, v91
v_mul_f32 v92, v12, v92
v_mul_f32 v93, v12, v93
v_mul_f32 v94, v12, v94
v_mul_f32 v95, v12, v95
v_mul_f32 v96, v12, v96
v_mul_f32 v97, v12, v97
v_mul_f32 v98, v12, v98
v_mul_f32 v99, v12, v99
v_mul_f32 v100, v12, v100
v_mul_f32 v101, v12, v101
v_mul_f32 v102, v12, v102
v_mul_f32 v103, v12, v103
v_mul_f32 v104, v12, v104
v_mul_f32 v105, v12, v105
v_mul_f32 v106, v12, v106
v_mul_f32 v107, v12, v107
v_mul_f32 v108, v12, v108
v_mul_f32 v109, v12, v109
v_mul_f32 v110, v12, v110
v_mul_f32 v111, v12, v111
v_mul_f32 v112, v12, v112
v_mul_f32 v113, v12, v113
v_mul_f32 v114, v12, v114
v_mul_f32 v115, v12, v115
v_mul_f32 v116, v12, v116
v_mul_f32 v117, v12, v117
v_mul_f32 v118, v12, v118
v_mul_f32 v119, v12, v119
v_mul_f32 v120, v12, v120
v_mul_f32 v121, v12, v121
v_mul_f32 v122, v12, v122
v_mul_f32 v123, v12, v123
v_mul_f32 v124, v12, v124
v_mul_f32 v125, v12, v125
v_mul_f32 v126, v12, v126
v_mul_f32 v127, v12, v127
L1_nr2:
s_waitcnt lgkmcnt(5)
v_mfma_f32_32x32x16_bf16 v[128:143], v[208:211], v[32:35], v[240:255]
ds_read_b128 v[232:235], v30 offset:0
v_exp_f32 v172, v172
v_exp_f32 v173, v173
v_cvt_pk_bf16_f32 v192, v160, v161
v_exp_f32 v174, v174
s_waitcnt lgkmcnt(5)
v_mfma_f32_32x32x16_bf16 v[128:143], v[212:215], v[36:39], v[128:143]
ds_read_b128 v[236:239], v31 offset:0
s_add_u32 m0, s65, 65536
s_add_u32 s59, s58, 65536
buffer_load_dwordx4 v3, s[40:43], s59 offen offset:2048 nt lds
v_exp_f32 v175, v175
v_cvt_pk_bf16_f32 v193, v162, v163
v_add_f32 v10, v10, v172
s_waitcnt lgkmcnt(5)
v_mfma_f32_32x32x16_bf16 v[128:143], v[216:219], v[40:43], v[128:143]
ds_read_b128 v[208:211], v24 offset:2048
v_add_f32 v11, v11, v173
v_cvt_pk_bf16_f32 v198, v172, v173
v_exp_f32 v176, v176
v_exp_f32 v177, v177
s_waitcnt lgkmcnt(5)
v_mfma_f32_32x32x16_bf16 v[128:143], v[220:223], v[44:47], v[128:143]
ds_read_b128 v[212:215], v25 offset:2048
v_cvt_pk_bf16_f32 v194, v164, v165
v_add_f32 v10, v10, v174
v_add_f32 v11, v11, v175
v_cvt_pk_bf16_f32 v199, v174, v175
s_waitcnt lgkmcnt(5)
v_mfma_f32_32x32x16_bf16 v[128:143], v[224:227], v[48:51], v[128:143]
ds_read_b128 v[216:219], v26 offset:2048
v_exp_f32 v178, v178
v_exp_f32 v179, v179
v_cvt_pk_bf16_f32 v195, v166, v167
s_waitcnt lgkmcnt(5)
v_mfma_f32_32x32x16_bf16 v[128:143], v[228:231], v[52:55], v[128:143]
ds_read_b128 v[220:223], v27 offset:2048
s_add_u32 m0, s65, 65536
s_add_u32 s59, s58, 65536
buffer_load_dwordx4 v3, s[40:43], s59 offen offset:3072 nt lds
v_add_f32 v10, v10, v176
v_add_f32 v11, v11, v177
v_cvt_pk_bf16_f32 v200, v176, v177
v_exp_f32 v180, v180
s_waitcnt lgkmcnt(5)
v_mfma_f32_32x32x16_bf16 v[128:143], v[232:235], v[56:59], v[128:143]
ds_read_b128 v[224:227], v28 offset:2048
v_exp_f32 v181, v181
v_cvt_pk_bf16_f32 v196, v168, v169
v_add_f32 v10, v10, v178
v_add_f32 v11, v11, v179
s_waitcnt lgkmcnt(5)
v_mfma_f32_32x32x16_bf16 v[128:143], v[236:239], v[60:63], v[128:143]
ds_read_b128 v[228:231], v29 offset:2048
v_cvt_pk_bf16_f32 v201, v178, v179
v_exp_f32 v182, v182
v_exp_f32 v183, v183
s_waitcnt lgkmcnt(5)
v_mfma_f32_32x32x16_bf16 v[144:159], v[208:211], v[32:35], v[240:255]
ds_read_b128 v[232:235], v30 offset:2048
v_cvt_pk_bf16_f32 v197, v170, v171
v_add_f32 v10, v10, v180
v_add_f32 v11, v11, v181
v_cvt_pk_bf16_f32 v202, v180, v181
v_exp_f32 v184, v184
s_waitcnt lgkmcnt(5)
v_mfma_f32_32x32x16_bf16 v[144:159], v[212:215], v[36:39], v[144:159]
ds_read_b128 v[236:239], v31 offset:2048
v_add_u32 v20, 0, v7
v_xor_b32 v21, 64, v20
v_xor_b32 v22, 128, v20
v_xor_b32 v23, 192, v20
s_waitcnt vmcnt(8)
s_barrier
s_add_u32 m0, s65, 98304
s_add_u32 s59, s58, 98304
buffer_load_dwordx4 v2, s[36:39], s59 offen offset:0 nt lds
v_exp_f32 v185, v185
v_add_f32 v10, v10, v182
v_add_f32 v11, v11, v183
s_waitcnt lgkmcnt(5)
v_mfma_f32_32x32x16_bf16 v[144:159], v[216:219], v[40:43], v[144:159]
ds_read_b64_tr_b16 v[208:209], v20 offset:0
ds_read_b64_tr_b16 v[210:211], v20 offset:8192
v_cvt_pk_bf16_f32 v203, v182, v183
v_exp_f32 v186, v186
v_exp_f32 v187, v187
s_waitcnt lgkmcnt(6)
v_mfma_f32_32x32x16_bf16 v[144:159], v[220:223], v[44:47], v[144:159]
ds_read_b64_tr_b16 v[212:213], v21 offset:0
ds_read_b64_tr_b16 v[214:215], v21 offset:8192
v_add_f32 v10, v10, v184
v_add_f32 v11, v11, v185
v_cvt_pk_bf16_f32 v204, v184, v185
v_exp_f32 v188, v188
s_waitcnt lgkmcnt(7)
v_mfma_f32_32x32x16_bf16 v[144:159], v[224:227], v[48:51], v[144:159]
ds_read_b64_tr_b16 v[216:217], v22 offset:0
ds_read_b64_tr_b16 v[218:219], v22 offset:8192
v_exp_f32 v189, v189
v_add_f32 v10, v10, v186
v_add_f32 v11, v11, v187
v_cvt_pk_bf16_f32 v205, v186, v187
s_waitcnt lgkmcnt(8)
v_mfma_f32_32x32x16_bf16 v[144:159], v[228:231], v[52:55], v[144:159]
ds_read_b64_tr_b16 v[220:221], v23 offset:0
ds_read_b64_tr_b16 v[222:223], v23 offset:8192
s_add_u32 m0, s65, 98304
s_add_u32 s59, s58, 98304
buffer_load_dwordx4 v2, s[36:39], s59 offen offset:1024 nt lds
v_exp_f32 v190, v190
v_exp_f32 v191, v191
v_add_f32 v10, v10, v188
s_waitcnt lgkmcnt(9)
v_mfma_f32_32x32x16_bf16 v[144:159], v[232:235], v[56:59], v[144:159]
ds_read_b64_tr_b16 v[224:225], v20 offset:1024
ds_read_b64_tr_b16 v[226:227], v20 offset:9216
v_add_f32 v11, v11, v189
v_cvt_pk_bf16_f32 v206, v188, v189
v_add_f32 v10, v10, v190
v_add_f32 v11, v11, v191
v_cvt_pk_bf16_f32 v207, v190, v191
s_waitcnt lgkmcnt(10)
v_mfma_f32_32x32x16_bf16 v[144:159], v[236:239], v[60:63], v[144:159]
ds_read_b64_tr_b16 v[228:229], v21 offset:1024
ds_read_b64_tr_b16 v[230:231], v21 offset:9216
s_waitcnt lgkmcnt(10)
v_mfma_f32_32x32x16_bf16 v[64:79], v[208:211], v[192:195], v[64:79]
ds_read_b64_tr_b16 v[232:233], v22 offset:1024
ds_read_b64_tr_b16 v[234:235], v22 offset:9216
v_max3_f32 v13, v128, v129, v130
v_max3_f32 v13, v131, v132, v13
v_max3_f32 v13, v133, v134, v13
v_max3_f32 v13, v135, v136, v13
s_waitcnt lgkmcnt(10)
v_mfma_f32_32x32x16_bf16 v[80:95], v[212:215], v[192:195], v[80:95]
ds_read_b64_tr_b16 v[236:237], v23 offset:1024
ds_read_b64_tr_b16 v[238:239], v23 offset:9216
s_add_u32 m0, s65, 98304
s_add_u32 s59, s58, 98304
buffer_load_dwordx4 v2, s[36:39], s59 offen offset:2048 nt lds
v_max3_f32 v13, v137, v138, v13
v_max3_f32 v13, v139, v140, v13
v_max3_f32 v13, v141, v142, v13
s_waitcnt lgkmcnt(10)
v_mfma_f32_32x32x16_bf16 v[96:111], v[216:219], v[192:195], v[96:111]
ds_read_b64_tr_b16 v[208:209], v20 offset:2048
ds_read_b64_tr_b16 v[210:211], v20 offset:10240
v_max3_f32 v14, v144, v145, v143
v_max3_f32 v14, v146, v147, v14
v_max3_f32 v14, v148, v149, v14
s_waitcnt lgkmcnt(10)
v_mfma_f32_32x32x16_bf16 v[112:127], v[220:223], v[192:195], v[112:127]
ds_read_b64_tr_b16 v[212:213], v21 offset:2048
ds_read_b64_tr_b16 v[214:215], v21 offset:10240
v_max3_f32 v14, v150, v151, v14
v_max3_f32 v14, v152, v153, v14
v_max3_f32 v14, v154, v155, v14
v_max3_f32 v14, v156, v157, v14
s_waitcnt lgkmcnt(10)
v_mfma_f32_32x32x16_bf16 v[64:79], v[224:227], v[196:199], v[64:79]
ds_read_b64_tr_b16 v[216:217], v22 offset:2048
ds_read_b64_tr_b16 v[218:219], v22 offset:10240
v_max3_f32 v14, v158, v159, v14
v_max_f32 v13, v13, v14
v_cmp_lt_f32 vcc, 0x41000000, v13
s_nop 0
s_cbranch_vccz L1_ok4
v_mov_b32 v14, v13
s_nop 1
v_permlane32_swap_b32 v13, v14
s_nop 1
v_max_f32 v13, v13, v14
v_cmp_lt_f32 vcc, 0x41000000, v13
s_nop 1
v_cndmask_b32 v13, 0, v13, vcc
v_exp_f32 v12, -v13
v_sub_f32 v128, v128, v13
v_sub_f32 v129, v129, v13
v_sub_f32 v130, v130, v13
v_sub_f32 v131, v131, v13
v_sub_f32 v132, v132, v13
v_sub_f32 v133, v133, v13
v_sub_f32 v134, v134, v13
v_sub_f32 v135, v135, v13
v_sub_f32 v136, v136, v13
v_sub_f32 v137, v137, v13
v_sub_f32 v138, v138, v13
v_sub_f32 v139, v139, v13
v_sub_f32 v140, v140, v13
v_sub_f32 v141, v141, v13
v_sub_f32 v142, v142, v13
v_sub_f32 v143, v143, v13
v_sub_f32 v144, v144, v13
v_sub_f32 v145, v145, v13
v_sub_f32 v146, v146, v13
v_sub_f32 v147, v147, v13
v_sub_f32 v148, v148, v13
v_sub_f32 v149, v149, v13
v_sub_f32 v150, v150, v13
v_sub_f32 v151, v151, v13
v_sub_f32 v152, v152, v13
v_sub_f32 v153, v153, v13
v_sub_f32 v154, v154, v13
v_sub_f32 v155, v155, v13
v_sub_f32 v156, v156, v13
v_sub_f32 v157, v157, v13
v_sub_f32 v158, v158, v13
v_sub_f32 v159, v159, v13
v_sub_f32 v240, v240, v13
v_sub_f32 v241, v241, v13
v_sub_f32 v242, v242, v13
v_sub_f32 v243, v243, v13
v_sub_f32 v244, v244, v13
v_sub_f32 v245, v245, v13
v_sub_f32 v246, v246, v13
v_sub_f32 v247, v247, v13
v_sub_f32 v248, v248, v13
v_sub_f32 v249, v249, v13
v_sub_f32 v250, v250, v13
v_sub_f32 v251, v251, v13
v_sub_f32 v252, v252, v13
v_sub_f32 v253, v253, v13
v_sub_f32 v254, v254, v13
v_sub_f32 v255, v255, v13
v_mul_f32 v10, v12, v10
v_mul_f32 v11, v12, v11
L1_ok4:
s_waitcnt lgkmcnt(10)
v_mfma_f32_32x32x16_bf16 v[80:95], v[228:231], v[196:199], v[80:95]
ds_read_b64_tr_b16 v[220:221], v23 offset:2048
ds_read_b64_tr_b16 v[222:223], v23 offset:10240
s_add_u32 m0, s65, 98304
s_add_u32 s59, s58, 98304
buffer_load_dwordx4 v2, s[36:39], s59 offen offset:3072 nt lds
v_exp_f32 v128, v128
v_exp_f32 v129, v129
s_waitcnt lgkmcnt(10)
v_mfma_f32_32x32x16_bf16 v[96:111], v[232:235], v[196:199], v[96:111]
ds_read_b64_tr_b16 v[224:225], v20 offset:3072
ds_read_b64_tr_b16 v[226:227], v20 offset:11264
v_exp_f32 v130, v130
v_exp_f32 v131, v131
s_waitcnt lgkmcnt(10)
v_mfma_f32_32x32x16_bf16 v[112:127], v[236:239], v[196:199], v[112:127]
ds_read_b64_tr_b16 v[228:229], v21 offset:3072
ds_read_b64_tr_b16 v[230:231], v21 offset:11264
v_add_f32 v10, v10, v128
v_add_f32 v11, v11, v129
s_waitcnt lgkmcnt(10)
v_mfma_f32_32x32x16_bf16 v[64:79], v[208:211], v[200:203], v[64:79]
ds_read_b64_tr_b16 v[232:233], v22 offset:3072
ds_read_b64_tr_b16 v[234:235], v22 offset:11264
v_exp_f32 v132, v132
v_exp_f32 v133, v133
s_waitcnt lgkmcnt(10)
v_mfma_f32_32x32x16_bf16 v[80:95], v[212:215], v[200:203], v[80:95]
ds_read_b64_tr_b16 v[236:237], v23 offset:3072
ds_read_b64_tr_b16 v[238:239], v23 offset:11264
v_add_u32 v24, 0, v6
v_xor_b32 v25, 32, v24
v_xor_b32 v26, 64, v24
v_xor_b32 v27, 96, v24
v_xor_b32 v28, 128, v24
v_xor_b32 v29, 160, v24
v_xor_b32 v30, 192, v24
v_xor_b32 v31, 224, v24
s_waitcnt vmcnt(8)
s_barrier
s_add_u32 m0, s65, 131072
s_add_u32 s59, s58, 81920
buffer_load_dwordx4 v3, s[40:43], s59 offen offset:0 nt lds
v_add_f32 v10, v10, v130
v_add_f32 v11, v11, v131
v_exp_f32 v134, v134
s_waitcnt lgkmcnt(10)
v_mfma_f32_32x32x16_bf16 v[96:111], v[216:219], v[200:203], v[96:111]
ds_read_b128 v[208:211], v24 offset:32768
v_exp_f32 v135, v135
s_waitcnt lgkmcnt(9)
v_mfma_f32_32x32x16_bf16 v[112:127], v[220:223], v[200:203], v[112:127]
ds_read_b128 v[212:215], v25 offset:32768
v_add_f32 v10, v10, v132
v_add_f32 v11, v11, v133
v_exp_f32 v136, v136
s_waitcnt lgkmcnt(8)
v_mfma_f32_32x32x16_bf16 v[64:79], v[224:227], v[204:207], v[64:79]
ds_read_b128 v[216:219], v26 offset:32768
v_exp_f32 v137, v137
v_add_f32 v10, v10, v134
s_waitcnt lgkmcnt(7)
v_mfma_f32_32x32x16_bf16 v[80:95], v[228:231], v[204:207], v[80:95]
ds_read_b128 v[220:223], v27 offset:32768
s_add_u32 m0, s65, 131072
s_add_u32 s59, s58, 81920
buffer_load_dwordx4 v3, s[40:43], s59 offen offset:1024 nt lds
v_add_f32 v11, v11, v135
v_exp_f32 v138, v138
s_waitcnt lgkmcnt(6)
v_mfma_f32_32x32x16_bf16 v[96:111], v[232:235], v[204:207], v[96:111]
ds_read_b128 v[224:227], v28 offset:32768
v_exp_f32 v139, v139
v_add_f32 v10, v10, v136
s_waitcnt lgkmcnt(5)
v_mfma_f32_32x32x16_bf16 v[112:127], v[236:239], v[204:207], v[112:127]
ds_read_b128 v[228:231], v29 offset:32768
v_add_f32 v11, v11, v137
v_add_f32 v10, v10, v138
v_add_f32 v11, v11, v139
s_cbranch_vccz L1_nr3
s_nop 7
s_nop 3
v_mul_f32 v64, v12, v64
v_mul_f32 v65, v12, v65
v_mul_f32 v66, v12, v66
v_mul_f32 v67, v12, v67
v_mul_f32 v68, v12, v68
v_mul_f32 v69, v12, v69
v_mul_f32 v70, v12, v70
v_mul_f32 v71, v12, v71
v_mul_f32 v72, v12, v72
v_mul_f32 v73, v12, v73
v_mul_f32 v74, v12, v74
v_mul_f32 v75, v12, v75
v_mul_f32 v76, v12, v76
v_mul_f32 v77, v12, v77
v_mul_f32 v78, v12, v78
v_mul_f32 v79, v12, v79
v_mul_f32 v80, v12, v80
v_mul_f32 v81, v12, v81
v_mul_f32 v82, v12, v82
v_mul_f32 v83, v12, v83
v_mul_f32 v84, v12, v84
v_mul_f32 v85, v12, v85
v_mul_f32 v86, v12, v86
v_mul_f32 v87, v12, v87
v_mul_f32 v88, v12, v88
v_mul_f32 v89, v12, v89
v_mul_f32 v90, v12, v90
v_mul_f32 v91, v12, v91
v_mul_f32 v92, v12, v92
v_mul_f32 v93, v12, v93
v_mul_f32 v94, v12, v94
v_mul_f32 v95, v12, v95
v_mul_f32 v96, v12, v96
v_mul_f32 v97, v12, v97
v_mul_f32 v98, v12, v98
v_mul_f32 v99, v12, v99
v_mul_f32 v100, v12, v100
v_mul_f32 v101, v12, v101
v_mul_f32 v102, v12, v102
v_mul_f32 v103, v12, v103
v_mul_f32 v104, v12, v104
v_mul_f32 v105, v12, v105
v_mul_f32 v106, v12, v106
v_mul_f32 v107, v12, v107
v_mul_f32 v108, v12, v108
v_mul_f32 v109, v12, v109
v_mul_f32 v110, v12, v110
v_mul_f32 v111, v12, v111
v_mul_f32 v112, v12, v112
v_mul_f32 v113, v12, v113
v_mul_f32 v114, v12, v114
v_mul_f32 v115, v12, v115
v_mul_f32 v116, v12, v116
v_mul_f32 v117, v12, v117
v_mul_f32 v118, v12, v118
v_mul_f32 v119, v12, v119
v_mul_f32 v120, v12, v120
v_mul_f32 v121, v12, v121
v_mul_f32 v122, v12, v122
v_mul_f32 v123, v12, v123
v_mul_f32 v124, v12, v124
v_mul_f32 v125, v12, v125
v_mul_f32 v126, v12, v126
v_mul_f32 v127, v12, v127
L1_nr3:
s_waitcnt lgkmcnt(5)
v_mfma_f32_32x32x16_bf16 v[160:175], v[208:211], v[32:35], v[240:255]
ds_read_b128 v[232:235], v30 offset:32768
v_exp_f32 v140, v140
v_exp_f32 v141, v141
v_cvt_pk_bf16_f32 v192, v128, v129
v_exp_f32 v142, v142
s_waitcnt lgkmcnt(5)
v_mfma_f32_32x32x16_bf16 v[160:175], v[212:215], v[36:39], v[160:175]
ds_read_b128 v[236:239], v31 offset:32768
s_add_u32 m0, s65, 131072
s_add_u32 s59, s58, 81920
buffer_load_dwordx4 v3, s[40:43], s59 offen offset:2048 nt lds
v_exp_f32 v143, v143
v_cvt_pk_bf16_f32 v193, v130, v131
v_add_f32 v10, v10, v140
s_waitcnt lgkmcnt(5)
v_mfma_f32_32x32x16_bf16 v[160:175], v[216:219], v[40:43], v[160:175]
ds_read_b128 v[208:211], v24 offset:34816
v_add_f32 v11, v11, v141
v_cvt_pk_bf16_f32 v198, v140, v141
v_exp_f32 v144, v144
v_exp_f32 v145, v145
s_waitcnt lgkmcnt(5)
v_mfma_f32_32x32x16_bf16 v[160:175], v[220:223], v[44:47], v[160:175]
ds_read_b128 v[212:215], v25 offset:34816
v_cvt_pk_bf16_f32 v194, v132, v133
v_add_f32 v10, v10, v142
v_add_f32 v11, v11, v143
v_cvt_pk_bf16_f32 v199, v142, v143
s_waitcnt lgkmcnt(5)
v_mfma_f32_32x32x16_bf16 v[160:175], v[224:227], v[48:51], v[160:175]
ds_read_b128 v[216:219], v26 offset:34816
v_exp_f32 v146, v146
v_exp_f32 v147, v147
v_cvt_pk_bf16_f32 v195, v134, v135
s_waitcnt lgkmcnt(5)
v_mfma_f32_32x32x16_bf16 v[160:175], v[228:231], v[52:55], v[160:175]
ds_read_b128 v[220:223], v27 offset:34816
s_add_u32 m0, s65, 131072
s_add_u32 s59, s58, 81920
buffer_load_dwordx4 v3, s[40:43], s59 offen offset:3072 nt lds
v_add_f32 v10, v10, v144
v_add_f32 v11, v11, v145
v_cvt_pk_bf16_f32 v200, v144, v145
v_exp_f32 v148, v148
s_waitcnt lgkmcnt(5)
v_mfma_f32_32x32x16_bf16 v[160:175], v[232:235], v[56:59], v[160:175]
ds_read_b128 v[224:227], v28 offset:34816
v_exp_f32 v149, v149
v_cvt_pk_bf16_f32 v196, v136, v137
v_add_f32 v10, v10, v146
v_add_f32 v11, v11, v147
s_waitcnt lgkmcnt(5)
v_mfma_f32_32x32x16_bf16 v[160:175], v[236:239], v[60:63], v[160:175]
ds_read_b128 v[228:231], v29 offset:34816
v_cvt_pk_bf16_f32 v201, v146, v147
v_exp_f32 v150, v150
v_exp_f32 v151, v151
s_waitcnt lgkmcnt(5)
v_mfma_f32_32x32x16_bf16 v[176:191], v[208:211], v[32:35], v[240:255]
ds_read_b128 v[232:235], v30 offset:34816
v_cvt_pk_bf16_f32 v197, v138, v139
v_add_f32 v10, v10, v148
v_add_f32 v11, v11, v149
v_cvt_pk_bf16_f32 v202, v148, v149
v_exp_f32 v152, v152
s_waitcnt lgkmcnt(5)
v_mfma_f32_32x32x16_bf16 v[176:191], v[212:215], v[36:39], v[176:191]
ds_read_b128 v[236:239], v31 offset:34816
v_add_u32 v20, 65536, v7
v_xor_b32 v21, 64, v20
v_xor_b32 v22, 128, v20
v_xor_b32 v23, 192, v20
s_waitcnt vmcnt(8)
s_barrier
s_add_u32 m0, s65, 0
s_add_u32 s59, s58, 114688
buffer_load_dwordx4 v2, s[36:39], s59 offen offset:0 nt lds
v_exp_f32 v153, v153
v_add_f32 v10, v10, v150
v_add_f32 v11, v11, v151
s_waitcnt lgkmcnt(5)
v_mfma_f32_32x32x16_bf16 v[176:191], v[216:219], v[40:43], v[176:191]
ds_read_b64_tr_b16 v[208:209], v20 offset:0
ds_read_b64_tr_b16 v[210:211], v20 offset:8192
v_cvt_pk_bf16_f32 v203, v150, v151
v_exp_f32 v154, v154
v_exp_f32 v155, v155
s_waitcnt lgkmcnt(6)
v_mfma_f32_32x32x16_bf16 v[176:191], v[220:223], v[44:47], v[176:191]
ds_read_b64_tr_b16 v[212:213], v21 offset:0
ds_read_b64_tr_b16 v[214:215], v21 offset:8192
v_add_f32 v10, v10, v152
v_add_f32 v11, v11, v153
v_cvt_pk_bf16_f32 v204, v152, v153
v_exp_f32 v156, v156
s_waitcnt lgkmcnt(7)
v_mfma_f32_32x32x16_bf16 v[176:191], v[224:227], v[48:51], v[176:191]
ds_read_b64_tr_b16 v[216:217], v22 offset:0
ds_read_b64_tr_b16 v[218:219], v22 offset:8192
v_exp_f32 v157, v157
v_add_f32 v10, v10, v154
v_add_f32 v11, v11, v155
v_cvt_pk_bf16_f32 v205, v154, v155
s_waitcnt lgkmcnt(8)
v_mfma_f32_32x32x16_bf16 v[176:191], v[228:231], v[52:55], v[176:191]
ds_read_b64_tr_b16 v[220:221], v23 offset:0
ds_read_b64_tr_b16 v[222:223], v23 offset:8192
s_add_u32 m0, s65, 0
s_add_u32 s59, s58, 114688
buffer_load_dwordx4 v2, s[36:39], s59 offen offset:1024 nt lds
v_exp_f32 v158, v158
v_exp_f32 v159, v159
v_add_f32 v10, v10, v156
s_waitcnt lgkmcnt(9)
v_mfma_f32_32x32x16_bf16 v[176:191], v[232:235], v[56:59], v[176:191]
ds_read_b64_tr_b16 v[224:225], v20 offset:1024
ds_read_b64_tr_b16 v[226:227], v20 offset:9216
v_add_f32 v11, v11, v157
v_cvt_pk_bf16_f32 v206, v156, v157
v_add_f32 v10, v10, v158
v_add_f32 v11, v11, v159
v_cvt_pk_bf16_f32 v207, v158, v159
s_waitcnt lgkmcnt(10)
v_mfma_f32_32x32x16_bf16 v[176:191], v[236:239], v[60:63], v[176:191]
ds_read_b64_tr_b16 v[228:229], v21 offset:1024
ds_read_b64_tr_b16 v[230:231], v21 offset:9216
s_waitcnt lgkmcnt(10)
v_mfma_f32_32x32x16_bf16 v[64:79], v[208:211], v[192:195], v[64:79]
ds_read_b64_tr_b16 v[232:233], v22 offset:1024
ds_read_b64_tr_b16 v[234:235], v22 offset:9216
v_max3_f32 v13, v160, v161, v162
v_max3_f32 v13, v163, v164, v13
v_max3_f32 v13, v165, v166, v13
v_max3_f32 v13, v167, v168, v13
s_waitcnt lgkmcnt(10)
v_mfma_f32_32x32x16_bf16 v[80:95], v[212:215], v[192:195], v[80:95]
ds_read_b64_tr_b16 v[236:237], v23 offset:1024
ds_read_b64_tr_b16 v[238:239], v23 offset:9216
s_add_u32 m0, s65, 0
s_add_u32 s59, s58, 114688
buffer_load_dwordx4 v2, s[36:39], s59 offen offset:2048 nt lds
v_max3_f32 v13, v169, v170, v13
v_max3_f32 v13, v171, v172, v13
v_max3_f32 v13, v173, v174, v13
s_waitcnt lgkmcnt(10)
v_mfma_f32_32x32x16_bf16 v[96:111], v[216:219], v[192:195], v[96:111]
ds_read_b64_tr_b16 v[208:209], v20 offset:2048
ds_read_b64_tr_b16 v[210:211], v20 offset:10240
v_max3_f32 v14, v176, v177, v175
v_max3_f32 v14, v178, v179, v14
v_max3_f32 v14, v180, v181, v14
s_waitcnt lgkmcnt(10)
v_mfma_f32_32x32x16_bf16 v[112:127], v[220:223], v[192:195], v[112:127]
ds_read_b64_tr_b16 v[212:213], v21 offset:2048
ds_read_b64_tr_b16 v[214:215], v21 offset:10240
v_max3_f32 v14, v182, v183, v14
v_max3_f32 v14, v184, v185, v14
v_max3_f32 v14, v186, v187, v14
v_max3_f32 v14, v188, v189, v14
s_waitcnt lgkmcnt(10)
v_mfma_f32_32x32x16_bf16 v[64:79], v[224:227], v[196:199], v[64:79]
ds_read_b64_tr_b16 v[216:217], v22 offset:2048
ds_read_b64_tr_b16 v[218:219], v22 offset:10240
v_max3_f32 v14, v190, v191, v14
v_max_f32 v13, v13, v14
v_cmp_lt_f32 vcc, 0x41000000, v13
s_nop 0
s_cbranch_vccz L1_ok5
v_mov_b32 v14, v13
s_nop 1
v_permlane32_swap_b32 v13, v14
s_nop 1
v_max_f32 v13, v13, v14
v_cmp_lt_f32 vcc, 0x41000000, v13
s_nop 1
v_cndmask_b32 v13, 0, v13, vcc
v_exp_f32 v12, -v13
v_sub_f32 v160, v160, v13
v_sub_f32 v161, v161, v13
v_sub_f32 v162, v162, v13
v_sub_f32 v163, v163, v13
v_sub_f32 v164, v164, v13
v_sub_f32 v165, v165, v13
v_sub_f32 v166, v166, v13
v_sub_f32 v167, v167, v13
v_sub_f32 v168, v168, v13
v_sub_f32 v169, v169, v13
v_sub_f32 v170, v170, v13
v_sub_f32 v171, v171, v13
v_sub_f32 v172, v172, v13
v_sub_f32 v173, v173, v13
v_sub_f32 v174, v174, v13
v_sub_f32 v175, v175, v13
v_sub_f32 v176, v176, v13
v_sub_f32 v177, v177, v13
v_sub_f32 v178, v178, v13
v_sub_f32 v179, v179, v13
v_sub_f32 v180, v180, v13
v_sub_f32 v181, v181, v13
v_sub_f32 v182, v182, v13
v_sub_f32 v183, v183, v13
v_sub_f32 v184, v184, v13
v_sub_f32 v185, v185, v13
v_sub_f32 v186, v186, v13
v_sub_f32 v187, v187, v13
v_sub_f32 v188, v188, v13
v_sub_f32 v189, v189, v13
v_sub_f32 v190, v190, v13
v_sub_f32 v191, v191, v13
v_sub_f32 v240, v240, v13
v_sub_f32 v241, v241, v13
v_sub_f32 v242, v242, v13
v_sub_f32 v243, v243, v13
v_sub_f32 v244, v244, v13
v_sub_f32 v245, v245, v13
v_sub_f32 v246, v246, v13
v_sub_f32 v247, v247, v13
v_sub_f32 v248, v248, v13
v_sub_f32 v249, v249, v13
v_sub_f32 v250, v250, v13
v_sub_f32 v251, v251, v13
v_sub_f32 v252, v252, v13
v_sub_f32 v253, v253, v13
v_sub_f32 v254, v254, v13
v_sub_f32 v255, v255, v13
v_mul_f32 v10, v12, v10
v_mul_f32 v11, v12, v11
L1_ok5:
s_waitcnt lgkmcnt(10)
v_mfma_f32_32x32x16_bf16 v[80:95], v[228:231], v[196:199], v[80:95]
ds_read_b64_tr_b16 v[220:221], v23 offset:2048
ds_read_b64_tr_b16 v[222:223], v23 offset:10240
s_add_u32 m0, s65, 0
s_add_u32 s59, s58, 114688
buffer_load_dwordx4 v2, s[36:39], s59 offen offset:3072 nt lds
v_exp_f32 v160, v160
v_exp_f32 v161, v161
s_waitcnt lgkmcnt(10)
v_mfma_f32_32x32x16_bf16 v[96:111], v[232:235], v[196:199], v[96:111]
ds_read_b64_tr_b16 v[224:225], v20 offset:3072
ds_read_b64_tr_b16 v[226:227], v20 offset:11264
v_exp_f32 v162, v162
v_exp_f32 v163, v163
s_waitcnt lgkmcnt(10)
v_mfma_f32_32x32x16_bf16 v[112:127], v[236:239], v[196:199], v[112:127]
ds_read_b64_tr_b16 v[228:229], v21 offset:3072
ds_read_b64_tr_b16 v[230:231], v21 offset:11264
v_add_f32 v10, v10, v160
v_add_f32 v11, v11, v161
s_waitcnt lgkmcnt(10)
v_mfma_f32_32x32x16_bf16 v[64:79], v[208:211], v[200:203], v[64:79]
ds_read_b64_tr_b16 v[232:233], v22 offset:3072
ds_read_b64_tr_b16 v[234:235], v22 offset:11264
v_exp_f32 v164, v164
v_exp_f32 v165, v165
s_waitcnt lgkmcnt(10)
v_mfma_f32_32x32x16_bf16 v[80:95], v[212:215], v[200:203], v[80:95]
ds_read_b64_tr_b16 v[236:237], v23 offset:3072
ds_read_b64_tr_b16 v[238:239], v23 offset:11264
v_add_u32 v24, 65536, v6
v_xor_b32 v25, 32, v24
v_xor_b32 v26, 64, v24
v_xor_b32 v27, 96, v24
v_xor_b32 v28, 128, v24
v_xor_b32 v29, 160, v24
v_xor_b32 v30, 192, v24
v_xor_b32 v31, 224, v24
s_waitcnt vmcnt(8)
s_barrier
s_add_u32 m0, s65, 32768
s_add_u32 s59, s58, 98304
buffer_load_dwordx4 v3, s[40:43], s59 offen offset:0 nt lds
v_add_f32 v10, v10, v162
v_add_f32 v11, v11, v163
v_exp_f32 v166, v166
s_waitcnt lgkmcnt(10)
v_mfma_f32_32x32x16_bf16 v[96:111], v[216:219], v[200:203], v[96:111]
ds_read_b128 v[208:211], v24 offset:32768
v_exp_f32 v167, v167
s_waitcnt lgkmcnt(9)
v_mfma_f32_32x32x16_bf16 v[112:127], v[220:223], v[200:203], v[112:127]
ds_read_b128 v[212:215], v25 offset:32768
v_add_f32 v10, v10, v164
v_add_f32 v11, v11, v165
v_exp_f32 v168, v168
s_waitcnt lgkmcnt(8)
v_mfma_f32_32x32x16_bf16 v[64:79], v[224:227], v[204:207], v[64:79]
ds_read_b128 v[216:219], v26 offset:32768
v_exp_f32 v169, v169
v_add_f32 v10, v10, v166
s_waitcnt lgkmcnt(7)
v_mfma_f32_32x32x16_bf16 v[80:95], v[228:231], v[204:207], v[80:95]
ds_read_b128 v[220:223], v27 offset:32768
s_add_u32 m0, s65, 32768
s_add_u32 s59, s58, 98304
buffer_load_dwordx4 v3, s[40:43], s59 offen offset:1024 nt lds
v_add_f32 v11, v11, v167
v_exp_f32 v170, v170
s_waitcnt lgkmcnt(6)
v_mfma_f32_32x32x16_bf16 v[96:111], v[232:235], v[204:207], v[96:111]
ds_read_b128 v[224:227], v28 offset:32768
v_exp_f32 v171, v171
v_add_f32 v10, v10, v168
s_waitcnt lgkmcnt(5)
v_mfma_f32_32x32x16_bf16 v[112:127], v[236:239], v[204:207], v[112:127]
ds_read_b128 v[228:231], v29 offset:32768
v_add_f32 v11, v11, v169
v_add_f32 v10, v10, v170
v_add_f32 v11, v11, v171
s_cbranch_vccz L1_nr4
s_nop 7
s_nop 3
v_mul_f32 v64, v12, v64
v_mul_f32 v65, v12, v65
v_mul_f32 v66, v12, v66
v_mul_f32 v67, v12, v67
v_mul_f32 v68, v12, v68
v_mul_f32 v69, v12, v69
v_mul_f32 v70, v12, v70
v_mul_f32 v71, v12, v71
v_mul_f32 v72, v12, v72
v_mul_f32 v73, v12, v73
v_mul_f32 v74, v12, v74
v_mul_f32 v75, v12, v75
v_mul_f32 v76, v12, v76
v_mul_f32 v77, v12, v77
v_mul_f32 v78, v12, v78
v_mul_f32 v79, v12, v79
v_mul_f32 v80, v12, v80
v_mul_f32 v81, v12, v81
v_mul_f32 v82, v12, v82
v_mul_f32 v83, v12, v83
v_mul_f32 v84, v12, v84
v_mul_f32 v85, v12, v85
v_mul_f32 v86, v12, v86
v_mul_f32 v87, v12, v87
v_mul_f32 v88, v12, v88
v_mul_f32 v89, v12, v89
v_mul_f32 v90, v12, v90
v_mul_f32 v91, v12, v91
v_mul_f32 v92, v12, v92
v_mul_f32 v93, v12, v93
v_mul_f32 v94, v12, v94
v_mul_f32 v95, v12, v95
v_mul_f32 v96, v12, v96
v_mul_f32 v97, v12, v97
v_mul_f32 v98, v12, v98
v_mul_f32 v99, v12, v99
v_mul_f32 v100, v12, v100
v_mul_f32 v101, v12, v101
v_mul_f32 v102, v12, v102
v_mul_f32 v103, v12, v103
v_mul_f32 v104, v12, v104
v_mul_f32 v105, v12, v105
v_mul_f32 v106, v12, v106
v_mul_f32 v107, v12, v107
v_mul_f32 v108, v12, v108
v_mul_f32 v109, v12, v109
v_mul_f32 v110, v12, v110
v_mul_f32 v111, v12, v111
v_mul_f32 v112, v12, v112
v_mul_f32 v113, v12, v113
v_mul_f32 v114, v12, v114
v_mul_f32 v115, v12, v115
v_mul_f32 v116, v12, v116
v_mul_f32 v117, v12, v117
v_mul_f32 v118, v12, v118
v_mul_f32 v119, v12, v119
v_mul_f32 v120, v12, v120
v_mul_f32 v121, v12, v121
v_mul_f32 v122, v12, v122
v_mul_f32 v123, v12, v123
v_mul_f32 v124, v12, v124
v_mul_f32 v125, v12, v125
v_mul_f32 v126, v12, v126
v_mul_f32 v127, v12, v127
L1_nr4:
s_waitcnt lgkmcnt(5)
v_mfma_f32_32x32x16_bf16 v[128:143], v[208:211], v[32:35], v[240:255]
ds_read_b128 v[232:235], v30 offset:32768
v_exp_f32 v172, v172
v_exp_f32 v173, v173
v_cvt_pk_bf16_f32 v192, v160, v161
v_exp_f32 v174, v174
s_waitcnt lgkmcnt(5)
v_mfma_f32_32x32x16_bf16 v[128:143], v[212:215], v[36:39], v[128:143]
ds_read_b128 v[236:239], v31 offset:32768
s_add_u32 m0, s65, 32768
s_add_u32 s59, s58, 98304
buffer_load_dwordx4 v3, s[40:43], s59 offen offset:2048 nt lds
v_exp_f32 v175, v175
v_cvt_pk_bf16_f32 v193, v162, v163
v_add_f32 v10, v10, v172
s_waitcnt lgkmcnt(5)
v_mfma_f32_32x32x16_bf16 v[128:143], v[216:219], v[40:43], v[128:143]
ds_read_b128 v[208:211], v24 offset:34816
v_add_f32 v11, v11, v173
v_cvt_pk_bf16_f32 v198, v172, v173
v_exp_f32 v176, v176
v_exp_f32 v177, v177
s_waitcnt lgkmcnt(5)
v_mfma_f32_32x32x16_bf16 v[128:143], v[220:223], v[44:47], v[128:143]
ds_read_b128 v[212:215], v25 offset:34816
v_cvt_pk_bf16_f32 v194, v164, v165
v_add_f32 v10, v10, v174
v_add_f32 v11, v11, v175
v_cvt_pk_bf16_f32 v199, v174, v175
s_waitcnt lgkmcnt(5)
v_mfma_f32_32x32x16_bf16 v[128:143], v[224:227], v[48:51], v[128:143]
ds_read_b128 v[216:219], v26 offset:34816
v_exp_f32 v178, v178
v_exp_f32 v179, v179
v_cvt_pk_bf16_f32 v195, v166, v167
s_waitcnt lgkmcnt(5)
v_mfma_f32_32x32x16_bf16 v[128:143], v[228:231], v[52:55], v[128:143]
ds_read_b128 v[220:223], v27 offset:34816
s_add_u32 m0, s65, 32768
s_add_u32 s59, s58, 98304
buffer_load_dwordx4 v3, s[40:43], s59 offen offset:3072 nt lds
v_add_f32 v10, v10, v176
v_add_f32 v11, v11, v177
v_cvt_pk_bf16_f32 v200, v176, v177
v_exp_f32 v180, v180
s_waitcnt lgkmcnt(5)
v_mfma_f32_32x32x16_bf16 v[128:143], v[232:235], v[56:59], v[128:143]
ds_read_b128 v[224:227], v28 offset:34816
v_exp_f32 v181, v181
v_cvt_pk_bf16_f32 v196, v168, v169
v_add_f32 v10, v10, v178
v_add_f32 v11, v11, v179
s_waitcnt lgkmcnt(5)
v_mfma_f32_32x32x16_bf16 v[128:143], v[236:239], v[60:63], v[128:143]
ds_read_b128 v[228:231], v29 offset:34816
v_cvt_pk_bf16_f32 v201, v178, v179
v_exp_f32 v182, v182
v_exp_f32 v183, v183
s_waitcnt lgkmcnt(5)
v_mfma_f32_32x32x16_bf16 v[144:159], v[208:211], v[32:35], v[240:255]
ds_read_b128 v[232:235], v30 offset:34816
v_cvt_pk_bf16_f32 v197, v170, v171
v_add_f32 v10, v10, v180
v_add_f32 v11, v11, v181
v_cvt_pk_bf16_f32 v202, v180, v181
v_exp_f32 v184, v184
s_waitcnt lgkmcnt(5)
v_mfma_f32_32x32x16_bf16 v[144:159], v[212:215], v[36:39], v[144:159]
ds_read_b128 v[236:239], v31 offset:34816
v_add_u32 v20, 131072, v7
v_xor_b32 v21, 64, v20
v_xor_b32 v22, 128, v20
v_xor_b32 v23, 192, v20
s_waitcnt vmcnt(8)
s_barrier
s_add_u32 m0, s65, 65536
s_add_u32 s59, s58, 114688
buffer_load_dwordx4 v3, s[40:43], s59 offen offset:0 nt lds
v_exp_f32 v185, v185
v_add_f32 v10, v10, v182
v_add_f32 v11, v11, v183
s_waitcnt lgkmcnt(5)
v_mfma_f32_32x32x16_bf16 v[144:159], v[216:219], v[40:43], v[144:159]
ds_read_b64_tr_b16 v[208:209], v20 offset:0
ds_read_b64_tr_b16 v[210:211], v20 offset:8192
v_cvt_pk_bf16_f32 v203, v182, v183
v_exp_f32 v186, v186
v_exp_f32 v187, v187
s_waitcnt lgkmcnt(6)
v_mfma_f32_32x32x16_bf16 v[144:159], v[220:223], v[44:47], v[144:159]
ds_read_b64_tr_b16 v[212:213], v21 offset:0
ds_read_b64_tr_b16 v[214:215], v21 offset:8192
v_add_f32 v10, v10, v184
v_add_f32 v11, v11, v185
v_cvt_pk_bf16_f32 v204, v184, v185
v_exp_f32 v188, v188
s_waitcnt lgkmcnt(7)
v_mfma_f32_32x32x16_bf16 v[144:159], v[224:227], v[48:51], v[144:159]
ds_read_b64_tr_b16 v[216:217], v22 offset:0
ds_read_b64_tr_b16 v[218:219], v22 offset:8192
v_exp_f32 v189, v189
v_add_f32 v10, v10, v186
v_add_f32 v11, v11, v187
v_cvt_pk_bf16_f32 v205, v186, v187
s_waitcnt lgkmcnt(8)
v_mfma_f32_32x32x16_bf16 v[144:159], v[228:231], v[52:55], v[144:159]
ds_read_b64_tr_b16 v[220:221], v23 offset:0
ds_read_b64_tr_b16 v[222:223], v23 offset:8192
s_add_u32 m0, s65, 65536
s_add_u32 s59, s58, 114688
buffer_load_dwordx4 v3, s[40:43], s59 offen offset:1024 nt lds
v_exp_f32 v190, v190
v_exp_f32 v191, v191
v_add_f32 v10, v10, v188
s_waitcnt lgkmcnt(9)
v_mfma_f32_32x32x16_bf16 v[144:159], v[232:235], v[56:59], v[144:159]
ds_read_b64_tr_b16 v[224:225], v20 offset:1024
ds_read_b64_tr_b16 v[226:227], v20 offset:9216
v_add_f32 v11, v11, v189
v_cvt_pk_bf16_f32 v206, v188, v189
v_add_f32 v10, v10, v190
v_add_f32 v11, v11, v191
v_cvt_pk_bf16_f32 v207, v190, v191
s_waitcnt lgkmcnt(10)
v_mfma_f32_32x32x16_bf16 v[144:159], v[236:239], v[60:63], v[144:159]
ds_read_b64_tr_b16 v[228:229], v21 offset:1024
ds_read_b64_tr_b16 v[230:231], v21 offset:9216
s_waitcnt lgkmcnt(10)
v_mfma_f32_32x32x16_bf16 v[64:79], v[208:211], v[192:195], v[64:79]
ds_read_b64_tr_b16 v[232:233], v22 offset:1024
ds_read_b64_tr_b16 v[234:235], v22 offset:9216
v_max3_f32 v13, v128, v129, v130
v_max3_f32 v13, v131, v132, v13
v_max3_f32 v13, v133, v134, v13
v_max3_f32 v13, v135, v136, v13
s_waitcnt lgkmcnt(10)
v_mfma_f32_32x32x16_bf16 v[80:95], v[212:215], v[192:195], v[80:95]
ds_read_b64_tr_b16 v[236:237], v23 offset:1024
ds_read_b64_tr_b16 v[238:239], v23 offset:9216
s_add_u32 m0, s65, 65536
s_add_u32 s59, s58, 114688
buffer_load_dwordx4 v3, s[40:43], s59 offen offset:2048 nt lds
v_max3_f32 v13, v137, v138, v13
v_max3_f32 v13, v139, v140, v13
v_max3_f32 v13, v141, v142, v13
s_waitcnt lgkmcnt(10)
v_mfma_f32_32x32x16_bf16 v[96:111], v[216:219], v[192:195], v[96:111]
ds_read_b64_tr_b16 v[208:209], v20 offset:2048
ds_read_b64_tr_b16 v[210:211], v20 offset:10240
v_max3_f32 v14, v144, v145, v143
v_max3_f32 v14, v146, v147, v14
v_max3_f32 v14, v148, v149, v14
s_waitcnt lgkmcnt(10)
v_mfma_f32_32x32x16_bf16 v[112:127], v[220:223], v[192:195], v[112:127]
ds_read_b64_tr_b16 v[212:213], v21 offset:2048
ds_read_b64_tr_b16 v[214:215], v21 offset:10240
v_max3_f32 v14, v150, v151, v14
v_max3_f32 v14, v152, v153, v14
v_max3_f32 v14, v154, v155, v14
v_max3_f32 v14, v156, v157, v14
s_waitcnt lgkmcnt(10)
v_mfma_f32_32x32x16_bf16 v[64:79], v[224:227], v[196:199], v[64:79]
ds_read_b64_tr_b16 v[216:217], v22 offset:2048
ds_read_b64_tr_b16 v[218:219], v22 offset:10240
v_max3_f32 v14, v158, v159, v14
v_max_f32 v13, v13, v14
v_cmp_lt_f32 vcc, 0x41000000, v13
s_nop 0
s_cbranch_vccz L1_ok6
v_mov_b32 v14, v13
s_nop 1
v_permlane32_swap_b32 v13, v14
s_nop 1
v_max_f32 v13, v13, v14
v_cmp_lt_f32 vcc, 0x41000000, v13
s_nop 1
v_cndmask_b32 v13, 0, v13, vcc
v_exp_f32 v12, -v13
v_sub_f32 v128, v128, v13
v_sub_f32 v129, v129, v13
v_sub_f32 v130, v130, v13
v_sub_f32 v131, v131, v13
v_sub_f32 v132, v132, v13
v_sub_f32 v133, v133, v13
v_sub_f32 v134, v134, v13
v_sub_f32 v135, v135, v13
v_sub_f32 v136, v136, v13
v_sub_f32 v137, v137, v13
v_sub_f32 v138, v138, v13
v_sub_f32 v139, v139, v13
v_sub_f32 v140, v140, v13
v_sub_f32 v141, v141, v13
v_sub_f32 v142, v142, v13
v_sub_f32 v143, v143, v13
v_sub_f32 v144, v144, v13
v_sub_f32 v145, v145, v13
v_sub_f32 v146, v146, v13
v_sub_f32 v147, v147, v13
v_sub_f32 v148, v148, v13
v_sub_f32 v149, v149, v13
v_sub_f32 v150, v150, v13
v_sub_f32 v151, v151, v13
v_sub_f32 v152, v152, v13
v_sub_f32 v153, v153, v13
v_sub_f32 v154, v154, v13
v_sub_f32 v155, v155, v13
v_sub_f32 v156, v156, v13
v_sub_f32 v157, v157, v13
v_sub_f32 v158, v158, v13
v_sub_f32 v159, v159, v13
v_sub_f32 v240, v240, v13
v_sub_f32 v241, v241, v13
v_sub_f32 v242, v242, v13
v_sub_f32 v243, v243, v13
v_sub_f32 v244, v244, v13
v_sub_f32 v245, v245, v13
v_sub_f32 v246, v246, v13
v_sub_f32 v247, v247, v13
v_sub_f32 v248, v248, v13
v_sub_f32 v249, v249, v13
v_sub_f32 v250, v250, v13
v_sub_f32 v251, v251, v13
v_sub_f32 v252, v252, v13
v_sub_f32 v253, v253, v13
v_sub_f32 v254, v254, v13
v_sub_f32 v255, v255, v13
v_mul_f32 v10, v12, v10
v_mul_f32 v11, v12, v11
L1_ok6:
s_waitcnt lgkmcnt(10)
v_mfma_f32_32x32x16_bf16 v[80:95], v[228:231], v[196:199], v[80:95]
ds_read_b64_tr_b16 v[220:221], v23 offset:2048
ds_read_b64_tr_b16 v[222:223], v23 offset:10240
s_add_u32 m0, s65, 65536
s_add_u32 s59, s58, 114688
buffer_load_dwordx4 v3, s[40:43], s59 offen offset:3072 nt lds
v_exp_f32 v128, v128
v_exp_f32 v129, v129
s_waitcnt lgkmcnt(10)
v_mfma_f32_32x32x16_bf16 v[96:111], v[232:235], v[196:199], v[96:111]
ds_read_b64_tr_b16 v[224:225], v20 offset:3072
ds_read_b64_tr_b16 v[226:227], v20 offset:11264
v_exp_f32 v130, v130
v_exp_f32 v131, v131
s_waitcnt lgkmcnt(10)
v_mfma_f32_32x32x16_bf16 v[112:127], v[236:239], v[196:199], v[112:127]
ds_read_b64_tr_b16 v[228:229], v21 offset:3072
ds_read_b64_tr_b16 v[230:231], v21 offset:11264
s_mov_b32 s98, s2
s_lshl_b32 s75, s52, 12
s_and_b32 s84, s98, 1
s_lshr_b32 s87, s98, 1
s_and_b32 s87, s87, 3
s_lshl_b32 s87, s87, 2
s_lshr_b32 s88, s98, 3
s_and_b32 s88, s88, 3
s_add_u32 s85, s87, s88
s_lshr_b32 s86, s98, 5
v_lshlrev_b32 v2, 4, v1
v_lshrrev_b32 v8, 3, v1
v_and_b32 v9, 7, v1
v_bfe_u32 v17, v1, 4, 1
v_lshlrev_b32 v17, 2, v17
v_xor_b32 v9, v9, v17
v_lshlrev_b32 v9, 4, v9
v_lshl_add_u32 v3, v8, 10, v9
s_cmp_eq_u32 s84, 1
s_cselect_b32 s32, s22, s12
s_cselect_b32 s33, s23, s13
s_mov_b32 s34, 0x400000
s_mov_b32 s35, 0x00020000
s_mov_b32 s36, s28
s_mov_b32 s37, s29
s_mov_b32 s38, 0x1000000
s_mov_b32 s39, 0x00020000
s_mov_b32 s40, s24
s_mov_b32 s41, s25
s_mov_b32 s42, 0x200000
s_mov_b32 s43, 0x00020000
s_lshl_b32 s89, s84, 4
s_add_u32 s89, s89, s85
s_lshl_b32 s89, s89, 19
s_lshl_b32 s87, s52, 15
s_add_u32 s89, s89, s87
s_add_u32 s90, s89, 0x40000
s_lshl_b32 s91, s52, 19
s_lshl_b32 s87, s86, 7
s_add_u32 s91, s91, s87
s_lshr_b32 s87, s52, 2
s_lshl_b32 s87, s87, 1
s_add_u32 s87, s87, s52
s_lshl_b32 s92, s87, 14
s_add_u32 s87, s85, s86
s_and_b32 s87, s87, 3
s_mov_b32 s94, 0x65832140
s_mov_b32 s95, 0xfedba9c7
s_cmp_eq_u32 s87, 1
s_cmov_b32 s94, 0x69432501
s_cmov_b32 s95, 0xfecbad87
s_cmp_eq_u32 s87, 2
s_cmov_b32 s94, 0xa5436102
s_cmov_b32 s95, 0xfdcbe987
s_cmp_eq_u32 s87, 3
s_cmov_b32 s94, 0x65472103
s_cmov_b32 s95, 0xedcfa98b
v_bfe_u32 v8, v1, 2, 2
v_lshrrev_b32 v9, 5, v1
v_lshl_add_u32 v9, v9, 2, v8
v_lshlrev_b32 v4, 7, v9
v_lshrrev_b32 v8, 1, v8
v_lshl_add_u32 v4, v8, 6, v4
v_and_b32 v8, 1, v1
v_lshl_add_u32 v4, v8, 5, v4
v_bfe_u32 v8, v1, 4, 1
v_lshl_add_u32 v4, v8, 4, v4
v_bfe_u32 v8, v1, 1, 1
v_lshl_add_u32 v4, v8, 3, v4
v_add_u32 v4, s75, v4
v_xor_b32 v5, 64, v4
v_add_f32 v10, v10, v128
v_add_f32 v11, v11, v129
s_waitcnt lgkmcnt(10)
v_mfma_f32_32x32x16_bf16 v[64:79], v[208:211], v[200:203], v[64:79]
ds_read_b64_tr_b16 v[232:233], v22 offset:3072
ds_read_b64_tr_b16 v[234:235], v22 offset:11264
v_exp_f32 v132, v132
v_exp_f32 v133, v133
s_waitcnt lgkmcnt(10)
v_mfma_f32_32x32x16_bf16 v[80:95], v[212:215], v[200:203], v[80:95]
ds_read_b64_tr_b16 v[236:237], v23 offset:3072
ds_read_b64_tr_b16 v[238:239], v23 offset:11264
v_add_u32 v24, 0, v6
v_xor_b32 v25, 32, v24
v_xor_b32 v26, 64, v24
v_xor_b32 v27, 96, v24
v_xor_b32 v28, 128, v24
v_xor_b32 v29, 160, v24
v_xor_b32 v30, 192, v24
v_xor_b32 v31, 224, v24
s_waitcnt vmcnt(8)
s_barrier
s_bfe_u32 s87, s94, 0x40000
s_lshl_b32 s93, s87, 15
s_add_u32 s93, s93, s91
s_add_u32 m0, s75, 98304
s_add_u32 s87, s93, 0
buffer_load_dwordx4 v3, s[32:35], s87 offen  lds
s_lshr_b32 s60, s2, 1
s_lshl_b32 s60, s60, 15
s_add_u32 s60, s60, s65
v_lshlrev_b32 v17, 6, v1
buffer_load_dword v18, v17, s[80:83], s60 offen
v_add_f32 v10, v10, v130
v_add_f32 v11, v11, v131
v_exp_f32 v134, v134
s_waitcnt lgkmcnt(10)
v_mfma_f32_32x32x16_bf16 v[96:111], v[216:219], v[200:203], v[96:111]
ds_read_b128 v[208:211], v24 offset:0
v_exp_f32 v135, v135
s_waitcnt lgkmcnt(9)
v_mfma_f32_32x32x16_bf16 v[112:127], v[220:223], v[200:203], v[112:127]
ds_read_b128 v[212:215], v25 offset:0
s_add_u32 m0, s75, 99328
s_add_u32 s87, s93, 8192
buffer_load_dwordx4 v3, s[32:35], s87 offen  lds
v_add_f32 v10, v10, v132
v_add_f32 v11, v11, v133
v_exp_f32 v136, v136
s_waitcnt lgkmcnt(8)
v_mfma_f32_32x32x16_bf16 v[64:79], v[224:227], v[204:207], v[64:79]
ds_read_b128 v[216:219], v26 offset:0
v_exp_f32 v137, v137
v_add_f32 v10, v10, v134
s_waitcnt lgkmcnt(7)
v_mfma_f32_32x32x16_bf16 v[80:95], v[228:231], v[204:207], v[80:95]
ds_read_b128 v[220:223], v27 offset:0
s_add_u32 m0, s75, 100352
s_add_u32 s87, s93, 16384
buffer_load_dwordx4 v3, s[32:35], s87 offen  lds
v_add_f32 v11, v11, v135
v_exp_f32 v138, v138
s_waitcnt lgkmcnt(6)
v_mfma_f32_32x32x16_bf16 v[96:111], v[232:235], v[204:207], v[96:111]
ds_read_b128 v[224:227], v28 offset:0
v_exp_f32 v139, v139
v_add_f32 v10, v10, v136
s_waitcnt lgkmcnt(5)
v_mfma_f32_32x32x16_bf16 v[112:127], v[236:239], v[204:207], v[112:127]
ds_read_b128 v[228:231], v29 offset:0
s_add_u32 m0, s75, 101376
s_add_u32 s87, s93, 24576
buffer_load_dwordx4 v3, s[32:35], s87 offen  lds
v_add_f32 v11, v11, v137
v_add_f32 v10, v10, v138
v_add_f32 v11, v11, v139
s_cbranch_vccz L1_nr5
s_nop 7
s_nop 3
v_mul_f32 v64, v12, v64
v_mul_f32 v65, v12, v65
v_mul_f32 v66, v12, v66
v_mul_f32 v67, v12, v67
v_mul_f32 v68, v12, v68
v_mul_f32 v69, v12, v69
v_mul_f32 v70, v12, v70
v_mul_f32 v71, v12, v71
v_mul_f32 v72, v12, v72
v_mul_f32 v73, v12, v73
v_mul_f32 v74, v12, v74
v_mul_f32 v75, v12, v75
v_mul_f32 v76, v12, v76
v_mul_f32 v77, v12, v77
v_mul_f32 v78, v12, v78
v_mul_f32 v79, v12, v79
v_mul_f32 v80, v12, v80
v_mul_f32 v81, v12, v81
v_mul_f32 v82, v12, v82
v_mul_f32 v83, v12, v83
v_mul_f32 v84, v12, v84
v_mul_f32 v85, v12, v85
v_mul_f32 v86, v12, v86
v_mul_f32 v87, v12, v87
v_mul_f32 v88, v12, v88
v_mul_f32 v89, v12, v89
v_mul_f32 v90, v12, v90
v_mul_f32 v91, v12, v91
v_mul_f32 v92, v12, v92
v_mul_f32 v93, v12, v93
v_mul_f32 v94, v12, v94
v_mul_f32 v95, v12, v95
v_mul_f32 v96, v12, v96
v_mul_f32 v97, v12, v97
v_mul_f32 v98, v12, v98
v_mul_f32 v99, v12, v99
v_mul_f32 v100, v12, v100
v_mul_f32 v101, v12, v101
v_mul_f32 v102, v12, v102
v_mul_f32 v103, v12, v103
v_mul_f32 v104, v12, v104
v_mul_f32 v105, v12, v105
v_mul_f32 v106, v12, v106
v_mul_f32 v107, v12, v107
v_mul_f32 v108, v12, v108
v_mul_f32 v109, v12, v109
v_mul_f32 v110, v12, v110
v_mul_f32 v111, v12, v111
v_mul_f32 v112, v12, v112
v_mul_f32 v113, v12, v113
v_mul_f32 v114, v12, v114
v_mul_f32 v115, v12, v115
v_mul_f32 v116, v12, v116
v_mul_f32 v117, v12, v117
v_mul_f32 v118, v12, v118
v_mul_f32 v119, v12, v119
v_mul_f32 v120, v12, v120
v_mul_f32 v121, v12, v121
v_mul_f32 v122, v12, v122
v_mul_f32 v123, v12, v123
v_mul_f32 v124, v12, v124
v_mul_f32 v125, v12, v125
v_mul_f32 v126, v12, v126
v_mul_f32 v127, v12, v127
L1_nr5:
s_waitcnt lgkmcnt(5)
v_mfma_f32_32x32x16_bf16 v[160:175], v[208:211], v[32:35], v[240:255]
ds_read_b128 v[232:235], v30 offset:0
v_exp_f32 v140, v140
v_exp_f32 v141, v141
v_cvt_pk_bf16_f32 v192, v128, v129
v_exp_f32 v142, v142
s_waitcnt lgkmcnt(5)
v_mfma_f32_32x32x16_bf16 v[160:175], v[212:215], v[36:39], v[160:175]
ds_read_b128 v[236:239], v31 offset:0
v_exp_f32 v143, v143
v_cvt_pk_bf16_f32 v193, v130, v131
v_add_f32 v10, v10, v140
s_waitcnt lgkmcnt(5)
v_mfma_f32_32x32x16_bf16 v[160:175], v[216:219], v[40:43], v[160:175]
ds_read_b128 v[208:211], v24 offset:2048
v_add_f32 v11, v11, v141
v_cvt_pk_bf16_f32 v198, v140, v141
v_exp_f32 v144, v144
v_exp_f32 v145, v145
s_waitcnt lgkmcnt(5)
v_mfma_f32_32x32x16_bf16 v[160:175], v[220:223], v[44:47], v[160:175]
ds_read_b128 v[212:215], v25 offset:2048
v_cvt_pk_bf16_f32 v194, v132, v133
v_add_f32 v10, v10, v142
v_add_f32 v11, v11, v143
v_cvt_pk_bf16_f32 v199, v142, v143
s_waitcnt lgkmcnt(5)
v_mfma_f32_32x32x16_bf16 v[160:175], v[224:227], v[48:51], v[160:175]
ds_read_b128 v[216:219], v26 offset:2048
v_exp_f32 v146, v146
v_exp_f32 v147, v147
v_cvt_pk_bf16_f32 v195, v134, v135
s_waitcnt lgkmcnt(5)
v_mfma_f32_32x32x16_bf16 v[160:175], v[228:231], v[52:55], v[160:175]
ds_read_b128 v[220:223], v27 offset:2048
v_add_f32 v10, v10, v144
v_add_f32 v11, v11, v145
v_cvt_pk_bf16_f32 v200, v144, v145
v_exp_f32 v148, v148
s_waitcnt lgkmcnt(5)
v_mfma_f32_32x32x16_bf16 v[160:175], v[232:235], v[56:59], v[160:175]
ds_read_b128 v[224:227], v28 offset:2048
v_exp_f32 v149, v149
v_cvt_pk_bf16_f32 v196, v136, v137
v_add_f32 v10, v10, v146
v_add_f32 v11, v11, v147
s_waitcnt lgkmcnt(5)
v_mfma_f32_32x32x16_bf16 v[160:175], v[236:239], v[60:63], v[160:175]
ds_read_b128 v[228:231], v29 offset:2048
v_cvt_pk_bf16_f32 v201, v146, v147
v_exp_f32 v150, v150
v_exp_f32 v151, v151
s_waitcnt lgkmcnt(5)
v_mfma_f32_32x32x16_bf16 v[176:191], v[208:211], v[32:35], v[240:255]
ds_read_b128 v[232:235], v30 offset:2048
v_cvt_pk_bf16_f32 v197, v138, v139
v_add_f32 v10, v10, v148
v_add_f32 v11, v11, v149
v_cvt_pk_bf16_f32 v202, v148, v149
v_exp_f32 v152, v152
s_waitcnt lgkmcnt(5)
v_mfma_f32_32x32x16_bf16 v[176:191], v[212:215], v[36:39], v[176:191]
ds_read_b128 v[236:239], v31 offset:2048
v_add_u32 v20, 0, v7
v_xor_b32 v21, 64, v20
v_xor_b32 v22, 128, v20
v_xor_b32 v23, 192, v20
s_waitcnt vmcnt(9)
s_barrier
s_bfe_u32 s87, s94, 0x40004
s_lshl_b32 s93, s87, 15
s_add_u32 s93, s93, s91
s_add_u32 m0, s75, 131072
s_add_u32 s87, s93, 0
buffer_load_dwordx4 v3, s[32:35], s87 offen  lds
v_exp_f32 v153, v153
v_add_f32 v10, v10, v150
v_add_f32 v11, v11, v151
s_waitcnt lgkmcnt(5)
v_mfma_f32_32x32x16_bf16 v[176:191], v[216:219], v[40:43], v[176:191]
ds_read_b64_tr_b16 v[208:209], v20 offset:32768
ds_read_b64_tr_b16 v[210:211], v20 offset:40960
v_cvt_pk_bf16_f32 v203, v150, v151
v_exp_f32 v154, v154
v_exp_f32 v155, v155
s_waitcnt lgkmcnt(6)
v_mfma_f32_32x32x16_bf16 v[176:191], v[220:223], v[44:47], v[176:191]
ds_read_b64_tr_b16 v[212:213], v21 offset:32768
ds_read_b64_tr_b16 v[214:215], v21 offset:40960
s_add_u32 m0, s75, 132096
s_add_u32 s87, s93, 8192
buffer_load_dwordx4 v3, s[32:35], s87 offen  lds
v_add_f32 v10, v10, v152
v_add_f32 v11, v11, v153
v_cvt_pk_bf16_f32 v204, v152, v153
v_exp_f32 v156, v156
s_waitcnt lgkmcnt(7)
v_mfma_f32_32x32x16_bf16 v[176:191], v[224:227], v[48:51], v[176:191]
ds_read_b64_tr_b16 v[216:217], v22 offset:32768
ds_read_b64_tr_b16 v[218:219], v22 offset:40960
v_exp_f32 v157, v157
v_add_f32 v10, v10, v154
v_add_f32 v11, v11, v155
v_cvt_pk_bf16_f32 v205, v154, v155
s_waitcnt lgkmcnt(8)
v_mfma_f32_32x32x16_bf16 v[176:191], v[228:231], v[52:55], v[176:191]
ds_read_b64_tr_b16 v[220:221], v23 offset:32768
ds_read_b64_tr_b16 v[222:223], v23 offset:40960
s_add_u32 m0, s75, 133120
s_add_u32 s87, s93, 16384
buffer_load_dwordx4 v3, s[32:35], s87 offen  lds
v_exp_f32 v158, v158
v_exp_f32 v159, v159
v_add_f32 v10, v10, v156
s_waitcnt lgkmcnt(9)
v_mfma_f32_32x32x16_bf16 v[176:191], v[232:235], v[56:59], v[176:191]
ds_read_b64_tr_b16 v[224:225], v20 offset:33792
ds_read_b64_tr_b16 v[226:227], v20 offset:41984
v_add_f32 v11, v11, v157
v_cvt_pk_bf16_f32 v206, v156, v157
v_add_f32 v10, v10, v158
v_add_f32 v11, v11, v159
v_cvt_pk_bf16_f32 v207, v158, v159
s_waitcnt lgkmcnt(10)
v_mfma_f32_32x32x16_bf16 v[176:191], v[236:239], v[60:63], v[176:191]
ds_read_b64_tr_b16 v[228:229], v21 offset:33792
ds_read_b64_tr_b16 v[230:231], v21 offset:41984
s_add_u32 m0, s75, 134144
s_add_u32 s87, s93, 24576
buffer_load_dwordx4 v3, s[32:35], s87 offen  lds
s_waitcnt lgkmcnt(10)
v_mfma_f32_32x32x16_bf16 v[64:79], v[208:211], v[192:195], v[64:79]
ds_read_b64_tr_b16 v[232:233], v22 offset:33792
ds_read_b64_tr_b16 v[234:235], v22 offset:41984
v_max3_f32 v13, v160, v161, v162
v_max3_f32 v13, v163, v164, v13
v_max3_f32 v13, v165, v166, v13
v_max3_f32 v13, v167, v168, v13
v_max3_f32 v13, v169, v170, v13
v_max3_f32 v13, v171, v172, v13
v_max3_f32 v13, v173, v174, v13
s_waitcnt lgkmcnt(10)
v_mfma_f32_32x32x16_bf16 v[80:95], v[212:215], v[192:195], v[80:95]
ds_read_b64_tr_b16 v[236:237], v23 offset:33792
ds_read_b64_tr_b16 v[238:239], v23 offset:41984
s_waitcnt lgkmcnt(10)
v_mfma_f32_32x32x16_bf16 v[96:111], v[216:219], v[192:195], v[96:111]
ds_read_b64_tr_b16 v[208:209], v20 offset:34816
ds_read_b64_tr_b16 v[210:211], v20 offset:43008
v_max3_f32 v14, v176, v177, v175
v_max3_f32 v14, v178, v179, v14
v_max3_f32 v14, v180, v181, v14
v_max3_f32 v14, v182, v183, v14
v_max3_f32 v14, v184, v185, v14
v_max3_f32 v14, v186, v187, v14
v_max3_f32 v14, v188, v189, v14
v_max3_f32 v14, v190, v191, v14
v_max_f32 v13, v13, v14
v_cmp_lt_f32 vcc, 0x41000000, v13
s_nop 0
s_cbranch_vccz L1_ok7
v_mov_b32 v14, v13
s_nop 1
v_permlane32_swap_b32 v13, v14
s_nop 1
v_max_f32 v13, v13, v14
v_cmp_lt_f32 vcc, 0x41000000, v13
s_nop 1
v_cndmask_b32 v13, 0, v13, vcc
v_exp_f32 v12, -v13
v_sub_f32 v160, v160, v13
v_sub_f32 v161, v161, v13
v_sub_f32 v162, v162, v13
v_sub_f32 v163, v163, v13
v_sub_f32 v164, v164, v13
v_sub_f32 v165, v165, v13
v_sub_f32 v166, v166, v13
v_sub_f32 v167, v167, v13
v_sub_f32 v168, v168, v13
v_sub_f32 v169, v169, v13
v_sub_f32 v170, v170, v13
v_sub_f32 v171, v171, v13
v_sub_f32 v172, v172, v13
v_sub_f32 v173, v173, v13
v_sub_f32 v174, v174, v13
v_sub_f32 v175, v175, v13
v_sub_f32 v176, v176, v13
v_sub_f32 v177, v177, v13
v_sub_f32 v178, v178, v13
v_sub_f32 v179, v179, v13
v_sub_f32 v180, v180, v13
v_sub_f32 v181, v181, v13
v_sub_f32 v182, v182, v13
v_sub_f32 v183, v183, v13
v_sub_f32 v184, v184, v13
v_sub_f32 v185, v185, v13
v_sub_f32 v186, v186, v13
v_sub_f32 v187, v187, v13
v_sub_f32 v188, v188, v13
v_sub_f32 v189, v189, v13
v_sub_f32 v190, v190, v13
v_sub_f32 v191, v191, v13
v_sub_f32 v240, v240, v13
v_sub_f32 v241, v241, v13
v_sub_f32 v242, v242, v13
v_sub_f32 v243, v243, v13
v_sub_f32 v244, v244, v13
v_sub_f32 v245, v245, v13
v_sub_f32 v246, v246, v13
v_sub_f32 v247, v247, v13
v_sub_f32 v248, v248, v13
v_sub_f32 v249, v249, v13
v_sub_f32 v250, v250, v13
v_sub_f32 v251, v251, v13
v_sub_f32 v252, v252, v13
v_sub_f32 v253, v253, v13
v_sub_f32 v254, v254, v13
v_sub_f32 v255, v255, v13
v_mul_f32 v10, v12, v10
v_mul_f32 v11, v12, v11
L1_ok7:
v_exp_f32 v160, v160
v_exp_f32 v161, v161
v_exp_f32 v162, v162
v_exp_f32 v163, v163
s_waitcnt lgkmcnt(10)
v_mfma_f32_32x32x16_bf16 v[112:127], v[220:223], v[192:195], v[112:127]
ds_read_b64_tr_b16 v[212:213], v21 offset:34816
ds_read_b64_tr_b16 v[214:215], v21 offset:43008
v_add_f32 v10, v10, v160
v_add_f32 v11, v11, v161
v_cvt_pk_bf16_f32 v240, v160, v161
v_exp_f32 v164, v164
v_exp_f32 v165, v165
v_add_f32 v10, v10, v162
s_waitcnt lgkmcnt(10)
v_mfma_f32_32x32x16_bf16 v[64:79], v[224:227], v[196:199], v[64:79]
ds_read_b64_tr_b16 v[216:217], v22 offset:34816
ds_read_b64_tr_b16 v[218:219], v22 offset:43008
v_add_f32 v11, v11, v163
v_cvt_pk_bf16_f32 v241, v162, v163
v_exp_f32 v166, v166
v_exp_f32 v167, v167
v_add_f32 v10, v10, v164
v_add_f32 v11, v11, v165
s_waitcnt lgkmcnt(10)
v_mfma_f32_32x32x16_bf16 v[80:95], v[228:231], v[196:199], v[80:95]
ds_read_b64_tr_b16 v[220:221], v23 offset:34816
ds_read_b64_tr_b16 v[222:223], v23 offset:43008
v_cvt_pk_bf16_f32 v242, v164, v165
v_exp_f32 v168, v168
v_exp_f32 v169, v169
v_add_f32 v10, v10, v166
v_add_f32 v11, v11, v167
v_cvt_pk_bf16_f32 v243, v166, v167
s_waitcnt lgkmcnt(10)
v_mfma_f32_32x32x16_bf16 v[96:111], v[232:235], v[196:199], v[96:111]
ds_read_b64_tr_b16 v[224:225], v20 offset:35840
ds_read_b64_tr_b16 v[226:227], v20 offset:44032
v_exp_f32 v170, v170
v_exp_f32 v171, v171
v_add_f32 v10, v10, v168
v_add_f32 v11, v11, v169
v_cvt_pk_bf16_f32 v244, v168, v169
v_exp_f32 v172, v172
s_waitcnt lgkmcnt(10)
v_mfma_f32_32x32x16_bf16 v[112:127], v[236:239], v[196:199], v[112:127]
ds_read_b64_tr_b16 v[228:229], v21 offset:35840
ds_read_b64_tr_b16 v[230:231], v21 offset:44032
v_exp_f32 v173, v173
v_add_f32 v10, v10, v170
v_add_f32 v11, v11, v171
v_cvt_pk_bf16_f32 v245, v170, v171
v_exp_f32 v174, v174
s_waitcnt lgkmcnt(10)
v_mfma_f32_32x32x16_bf16 v[64:79], v[208:211], v[200:203], v[64:79]
ds_read_b64_tr_b16 v[232:233], v22 offset:35840
ds_read_b64_tr_b16 v[234:235], v22 offset:44032
v_exp_f32 v175, v175
v_add_f32 v10, v10, v172
v_add_f32 v11, v11, v173
v_cvt_pk_bf16_f32 v246, v172, v173
v_exp_f32 v176, v176
v_exp_f32 v177, v177
s_waitcnt lgkmcnt(10)
v_mfma_f32_32x32x16_bf16 v[80:95], v[212:215], v[200:203], v[80:95]
ds_read_b64_tr_b16 v[236:237], v23 offset:35840
ds_read_b64_tr_b16 v[238:239], v23 offset:44032
v_add_u32 v20, 65536, v7
v_xor_b32 v21, 64, v20
v_xor_b32 v22, 128, v20
v_xor_b32 v23, 192, v20
s_waitcnt vmcnt(9)
s_barrier
s_bfe_u32 s87, s94, 0x40008
s_lshl_b32 s93, s87, 15
s_add_u32 s93, s93, s91
s_add_u32 m0, s75, 0
s_add_u32 s87, s93, 0
buffer_load_dwordx4 v3, s[32:35], s87 offen  lds
v_add_f32 v10, v10, v174
v_add_f32 v11, v11, v175
v_cvt_pk_bf16_f32 v247, v174, v175
v_exp_f32 v178, v178
v_exp_f32 v179, v179
s_waitcnt lgkmcnt(10)
v_mfma_f32_32x32x16_bf16 v[96:111], v[216:219], v[200:203], v[96:111]
ds_read_b64_tr_b16 v[208:209], v20 offset:0
ds_read_b64_tr_b16 v[210:211], v20 offset:8192
v_add_f32 v10, v10, v176
v_add_f32 v11, v11, v177
v_cvt_pk_bf16_f32 v248, v176, v177
v_exp_f32 v180, v180
v_exp_f32 v181, v181
v_add_f32 v10, v10, v178
s_waitcnt lgkmcnt(10)
v_mfma_f32_32x32x16_bf16 v[112:127], v[220:223], v[200:203], v[112:127]
ds_read_b64_tr_b16 v[212:213], v20 offset:1024
ds_read_b64_tr_b16 v[214:215], v20 offset:9216
s_add_u32 m0, s75, 1024
s_add_u32 s87, s93, 8192
buffer_load_dwordx4 v3, s[32:35], s87 offen  lds
v_add_f32 v11, v11, v179
v_cvt_pk_bf16_f32 v249, v178, v179
v_exp_f32 v182, v182
v_exp_f32 v183, v183
v_add_f32 v10, v10, v180
v_add_f32 v11, v11, v181
s_waitcnt lgkmcnt(10)
v_mfma_f32_32x32x16_bf16 v[64:79], v[224:227], v[204:207], v[64:79]
ds_read_b64_tr_b16 v[216:217], v20 offset:2048
ds_read_b64_tr_b16 v[218:219], v20 offset:10240
v_cvt_pk_bf16_f32 v250, v180, v181
v_exp_f32 v184, v184
v_exp_f32 v185, v185
v_add_f32 v10, v10, v182
v_add_f32 v11, v11, v183
v_cvt_pk_bf16_f32 v251, v182, v183
s_waitcnt lgkmcnt(10)
v_mfma_f32_32x32x16_bf16 v[80:95], v[228:231], v[204:207], v[80:95]
ds_read_b64_tr_b16 v[220:221], v20 offset:3072
ds_read_b64_tr_b16 v[222:223], v20 offset:11264
s_add_u32 m0, s75, 2048
s_add_u32 s87, s93, 16384
buffer_load_dwordx4 v3, s[32:35], s87 offen  lds
v_exp_f32 v186, v186
v_exp_f32 v187, v187
v_add_f32 v10, v10, v184
v_add_f32 v11, v11, v185
v_cvt_pk_bf16_f32 v252, v184, v185
v_exp_f32 v188, v188
s_waitcnt lgkmcnt(10)
v_mfma_f32_32x32x16_bf16 v[96:111], v[232:235], v[204:207], v[96:111]
ds_read_b64_tr_b16 v[224:225], v21 offset:0
ds_read_b64_tr_b16 v[226:227], v21 offset:8192
v_exp_f32 v189, v189
v_add_f32 v10, v10, v186
v_add_f32 v11, v11, v187
v_cvt_pk_bf16_f32 v253, v186, v187
v_exp_f32 v190, v190
s_waitcnt lgkmcnt(10)
v_mfma_f32_32x32x16_bf16 v[112:127], v[236:239], v[204:207], v[112:127]
ds_read_b64_tr_b16 v[228:229], v21 offset:1024
ds_read_b64_tr_b16 v[230:231], v21 offset:9216
s_add_u32 m0, s75, 3072
s_add_u32 s87, s93, 24576
buffer_load_dwordx4 v3, s[32:35], s87 offen  lds
v_exp_f32 v191, v191
v_add_f32 v10, v10, v188
v_add_f32 v11, v11, v189
v_cvt_pk_bf16_f32 v254, v188, v189
v_add_f32 v10, v10, v190
v_add_f32 v11, v11, v191
v_cvt_pk_bf16_f32 v255, v190, v191
s_cbranch_vccz L1_nr6
s_nop 7
s_nop 3
v_mul_f32 v64, v12, v64
v_mul_f32 v65, v12, v65
v_mul_f32 v66, v12, v66
v_mul_f32 v67, v12, v67
v_mul_f32 v68, v12, v68
v_mul_f32 v69, v12, v69
v_mul_f32 v70, v12, v70
v_mul_f32 v71, v12, v71
v_mul_f32 v72, v12, v72
v_mul_f32 v73, v12, v73
v_mul_f32 v74, v12, v74
v_mul_f32 v75, v12, v75
v_mul_f32 v76, v12, v76
v_mul_f32 v77, v12, v77
v_mul_f32 v78, v12, v78
v_mul_f32 v79, v12, v79
v_mul_f32 v80, v12, v80
v_mul_f32 v81, v12, v81
v_mul_f32 v82, v12, v82
v_mul_f32 v83, v12, v83
v_mul_f32 v84, v12, v84
v_mul_f32 v85, v12, v85
v_mul_f32 v86, v12, v86
v_mul_f32 v87, v12, v87
v_mul_f32 v88, v12, v88
v_mul_f32 v89, v12, v89
v_mul_f32 v90, v12, v90
v_mul_f32 v91, v12, v91
v_mul_f32 v92, v12, v92
v_mul_f32 v93, v12, v93
v_mul_f32 v94, v12, v94
v_mul_f32 v95, v12, v95
v_mul_f32 v96, v12, v96
v_mul_f32 v97, v12, v97
v_mul_f32 v98, v12, v98
v_mul_f32 v99, v12, v99
v_mul_f32 v100, v12, v100
v_mul_f32 v101, v12, v101
v_mul_f32 v102, v12, v102
v_mul_f32 v103, v12, v103
v_mul_f32 v104, v12, v104
v_mul_f32 v105, v12, v105
v_mul_f32 v106, v12, v106
v_mul_f32 v107, v12, v107
v_mul_f32 v108, v12, v108
v_mul_f32 v109, v12, v109
v_mul_f32 v110, v12, v110
v_mul_f32 v111, v12, v111
v_mul_f32 v112, v12, v112
v_mul_f32 v113, v12, v113
v_mul_f32 v114, v12, v114
v_mul_f32 v115, v12, v115
v_mul_f32 v116, v12, v116
v_mul_f32 v117, v12, v117
v_mul_f32 v118, v12, v118
v_mul_f32 v119, v12, v119
v_mul_f32 v120, v12, v120
v_mul_f32 v121, v12, v121
v_mul_f32 v122, v12, v122
v_mul_f32 v123, v12, v123
v_mul_f32 v124, v12, v124
v_mul_f32 v125, v12, v125
v_mul_f32 v126, v12, v126
v_mul_f32 v127, v12, v127
L1_nr6:
s_nop 1
s_waitcnt lgkmcnt(10)
v_mfma_f32_32x32x16_bf16 v[64:79], v[208:211], v[240:243], v[64:79]
ds_read_b64_tr_b16 v[232:233], v21 offset:2048
ds_read_b64_tr_b16 v[234:235], v21 offset:10240
s_barrier
v_add_f32 v10, v10, v11
v_lshlrev_b32 v16, 4, v1
v_mov_b32 v14, v10
s_nop 1
v_permlane32_swap_b32 v10, v14
s_nop 1
v_add_f32 v10, v10, v14
v_rcp_f32 v13, v10
s_lshl_b32 s59, s57, 3
s_add_u32 s59, s59, s56
s_lshl_b32 s59, s59, 2
s_add_u32 s59, s59, s54
s_lshl_b32 s59, s59, 5
s_add_u32 s59, s59, s55
s_lshl_b32 s59, s59, 13
s_add_u32 s60, s59, 4096
s_waitcnt lgkmcnt(10)
v_mfma_f32_32x32x16_bf16 v[64:79], v[212:215], v[244:247], v[64:79]
ds_read_b64_tr_b16 v[236:237], v21 offset:3072
ds_read_b64_tr_b16 v[238:239], v21 offset:11264
s_bfe_u32 s87, s94, 0x4000c
s_lshl_b32 s93, s87, 15
s_add_u32 s93, s93, s91
s_add_u32 m0, s75, 32768
s_add_u32 s87, s93, 0
buffer_load_dwordx4 v3, s[32:35], s87 offen  lds
s_waitcnt lgkmcnt(10)
v_mfma_f32_32x32x16_bf16 v[64:79], v[216:219], v[248:251], v[64:79]
ds_read_b64_tr_b16 v[208:209], v22 offset:0
ds_read_b64_tr_b16 v[210:211], v22 offset:8192
s_add_u32 m0, s75, 33792
s_add_u32 s87, s93, 8192
buffer_load_dwordx4 v3, s[32:35], s87 offen  lds
s_waitcnt lgkmcnt(10)
v_mfma_f32_32x32x16_bf16 v[64:79], v[220:223], v[252:255], v[64:79]
ds_read_b64_tr_b16 v[212:213], v22 offset:1024
ds_read_b64_tr_b16 v[214:215], v22 offset:9216
s_add_u32 m0, s75, 34816
s_add_u32 s87, s93, 16384
buffer_load_dwordx4 v3, s[32:35], s87 offen  lds
s_waitcnt lgkmcnt(10)
v_mfma_f32_32x32x16_bf16 v[80:95], v[224:227], v[240:243], v[80:95]
ds_read_b64_tr_b16 v[216:217], v22 offset:2048
ds_read_b64_tr_b16 v[218:219], v22 offset:10240
s_add_u32 m0, s75, 35840
s_add_u32 s87, s93, 24576
buffer_load_dwordx4 v3, s[32:35], s87 offen  lds
s_waitcnt lgkmcnt(10)
v_mfma_f32_32x32x16_bf16 v[80:95], v[228:231], v[244:247], v[80:95]
ds_read_b64_tr_b16 v[220:221], v22 offset:3072
ds_read_b64_tr_b16 v[222:223], v22 offset:11264
v_mul_f32 v64, v13, v64
v_mul_f32 v65, v13, v65
v_mul_f32 v66, v13, v66
v_mul_f32 v67, v13, v67
v_mul_f32 v68, v13, v68
v_mul_f32 v69, v13, v69
v_mul_f32 v70, v13, v70
v_mul_f32 v71, v13, v71
v_cvt_pk_bf16_f32 v128, v64, v65
v_cvt_pk_bf16_f32 v129, v66, v67
v_cvt_pk_bf16_f32 v130, v68, v69
v_cvt_pk_bf16_f32 v131, v70, v71
buffer_store_dwordx4 v[128:131], v16, s[48:51], s59 offen offset:0 sc1
v_mul_f32 v72, v13, v72
v_mul_f32 v73, v13, v73
v_mul_f32 v74, v13, v74
v_mul_f32 v75, v13, v75
v_mul_f32 v76, v13, v76
v_mul_f32 v77, v13, v77
v_mul_f32 v78, v13, v78
v_mul_f32 v79, v13, v79
v_cvt_pk_bf16_f32 v132, v72, v73
v_cvt_pk_bf16_f32 v133, v74, v75
v_cvt_pk_bf16_f32 v134, v76, v77
v_cvt_pk_bf16_f32 v135, v78, v79
buffer_store_dwordx4 v[132:135], v16, s[48:51], s59 offen offset:1024 sc1
s_waitcnt lgkmcnt(10)
v_mfma_f32_32x32x16_bf16 v[80:95], v[232:235], v[248:251], v[80:95]
ds_read_b64_tr_b16 v[224:225], v23 offset:0
ds_read_b64_tr_b16 v[226:227], v23 offset:8192
s_waitcnt lgkmcnt(10)
v_mfma_f32_32x32x16_bf16 v[80:95], v[236:239], v[252:255], v[80:95]
ds_read_b64_tr_b16 v[228:229], v23 offset:1024
ds_read_b64_tr_b16 v[230:231], v23 offset:9216
s_waitcnt lgkmcnt(10)
v_mfma_f32_32x32x16_bf16 v[96:111], v[208:211], v[240:243], v[96:111]
ds_read_b64_tr_b16 v[232:233], v23 offset:2048
ds_read_b64_tr_b16 v[234:235], v23 offset:10240
s_waitcnt lgkmcnt(10)
v_mfma_f32_32x32x16_bf16 v[96:111], v[212:215], v[244:247], v[96:111]
ds_read_b64_tr_b16 v[236:237], v23 offset:3072
ds_read_b64_tr_b16 v[238:239], v23 offset:11264
v_mul_f32 v80, v13, v80
v_mul_f32 v81, v13, v81
v_mul_f32 v82, v13, v82
v_mul_f32 v83, v13, v83
v_mul_f32 v84, v13, v84
v_mul_f32 v85, v13, v85
v_mul_f32 v86, v13, v86
v_mul_f32 v87, v13, v87
v_cvt_pk_bf16_f32 v136, v80, v81
v_cvt_pk_bf16_f32 v137, v82, v83
v_cvt_pk_bf16_f32 v138, v84, v85
v_cvt_pk_bf16_f32 v139, v86, v87
buffer_store_dwordx4 v[136:139], v16, s[48:51], s59 offen offset:2048 sc1
v_mul_f32 v88, v13, v88
v_mul_f32 v89, v13, v89
v_mul_f32 v90, v13, v90
v_mul_f32 v91, v13, v91
v_mul_f32 v92, v13, v92
v_mul_f32 v93, v13, v93
v_mul_f32 v94, v13, v94
v_mul_f32 v95, v13, v95
s_waitcnt lgkmcnt(10)
v_mfma_f32_32x32x16_bf16 v[96:111], v[216:219], v[248:251], v[96:111]
v_cvt_pk_bf16_f32 v140, v88, v89
v_cvt_pk_bf16_f32 v141, v90, v91
v_cvt_pk_bf16_f32 v142, v92, v93
v_cvt_pk_bf16_f32 v143, v94, v95
buffer_store_dwordx4 v[140:143], v16, s[48:51], s59 offen offset:3072 sc1
s_waitcnt lgkmcnt(8)
v_mfma_f32_32x32x16_bf16 v[96:111], v[220:223], v[252:255], v[96:111]
s_waitcnt lgkmcnt(6)
v_mfma_f32_32x32x16_bf16 v[112:127], v[224:227], v[240:243], v[112:127]
s_waitcnt lgkmcnt(4)
v_mfma_f32_32x32x16_bf16 v[112:127], v[228:231], v[244:247], v[112:127]
v_mul_f32 v96, v13, v96
v_mul_f32 v97, v13, v97
v_mul_f32 v98, v13, v98
v_mul_f32 v99, v13, v99
v_mul_f32 v100, v13, v100
v_mul_f32 v101, v13, v101
v_mul_f32 v102, v13, v102
v_mul_f32 v103, v13, v103
v_cvt_pk_bf16_f32 v144, v96, v97
v_cvt_pk_bf16_f32 v145, v98, v99
v_cvt_pk_bf16_f32 v146, v100, v101
v_cvt_pk_bf16_f32 v147, v102, v103
buffer_store_dwordx4 v[144:147], v16, s[48:51], s60 offen offset:0 sc1
v_mul_f32 v104, v13, v104
v_mul_f32 v105, v13, v105
v_mul_f32 v106, v13, v106
s_waitcnt lgkmcnt(2)
v_mfma_f32_32x32x16_bf16 v[112:127], v[232:235], v[248:251], v[112:127]
v_mul_f32 v107, v13, v107
v_mul_f32 v108, v13, v108
v_mul_f32 v109, v13, v109
v_mul_f32 v110, v13, v110
v_mul_f32 v111, v13, v111
s_waitcnt lgkmcnt(0)
v_mfma_f32_32x32x16_bf16 v[112:127], v[236:239], v[252:255], v[112:127]
v_cvt_pk_bf16_f32 v148, v104, v105
v_cvt_pk_bf16_f32 v149, v106, v107
v_cvt_pk_bf16_f32 v150, v108, v109
v_cvt_pk_bf16_f32 v151, v110, v111
buffer_store_dwordx4 v[148:151], v16, s[48:51], s60 offen offset:1024 sc1
s_nop 7
v_mul_f32 v112, v13, v112
v_mul_f32 v113, v13, v113
v_mul_f32 v114, v13, v114
v_mul_f32 v115, v13, v115
v_mul_f32 v116, v13, v116
v_mul_f32 v117, v13, v117
v_mul_f32 v118, v13, v118
v_mul_f32 v119, v13, v119
v_cvt_pk_bf16_f32 v152, v112, v113
v_cvt_pk_bf16_f32 v153, v114, v115
v_cvt_pk_bf16_f32 v154, v116, v117
v_cvt_pk_bf16_f32 v155, v118, v119
buffer_store_dwordx4 v[152:155], v16, s[48:51], s60 offen offset:2048 sc1
v_mul_f32 v120, v13, v120
v_mul_f32 v121, v13, v121
v_mul_f32 v122, v13, v122
v_mul_f32 v123, v13, v123
v_mul_f32 v124, v13, v124
v_mul_f32 v125, v13, v125
v_mul_f32 v126, v13, v126
v_mul_f32 v127, v13, v127
v_cvt_pk_bf16_f32 v156, v120, v121
v_cvt_pk_bf16_f32 v157, v122, v123
v_cvt_pk_bf16_f32 v158, v124, v125
v_cvt_pk_bf16_f32 v159, v126, v127
buffer_store_dwordx4 v[156:159], v16, s[48:51], s60 offen offset:3072 sc1
s_mov_b32 s68, s26
s_mov_b32 s69, s27
s_mov_b32 s70, 256
s_mov_b32 s71, 0x00020000
s_lshl_b32 s73, s57, 2
s_lshr_b32 s72, s2, 6
s_add_u32 s72, s72, s73
s_lshl_b32 s72, s72, 5
s_bfe_u32 s74, s2, 0x20001
s_add_u32 s73, s73, s74
s_lshl_b32 s73, s73, 5
s_mov_b32 s74, 6000
v_mov_b32 v11, 1
v_mov_b32 v9, 0x10000
s_waitcnt vmcnt(0)
s_barrier
s_cmp_lg_u32 s52, 0
s_cbranch_scc1 LF_m0
s_lshr_b32 s63, s2, 6
s_lshl_b32 s63, s63, 1
s_add_u32 s63, s63, s57
s_lshl_b32 s63, s63, 8
s_add_u32 s63, s63, 0x1000000
v_lshlrev_b32 v7, 11, v1
v_mov_b32 v8, 1
v_lshlrev_b32 v10, 2, v1
s_lshl_b32 s78, s55, 2
s_add_u32 s63, s63, s78
s_mov_b32 exec_lo, -1
s_mov_b32 exec_hi, 0
buffer_store_dword v8, v7, s[48:51], s63 offen sc1
s_mov_b64 exec, -1
LF_m0:
v_add_u32 v252, 98304, v4
v_add_u32 v253, 98304, v5
ds_read_b64_tr_b16 v[140:141], v252 offset:0
ds_read_b64_tr_b16 v[142:143], v252 offset:1024
ds_read_b64_tr_b16 v[144:145], v253 offset:0
ds_read_b64_tr_b16 v[146:147], v253 offset:1024
ds_read_b64_tr_b16 v[148:149], v252 offset:2048
ds_read_b64_tr_b16 v[150:151], v252 offset:3072
ds_read_b64_tr_b16 v[152:153], v253 offset:2048
ds_read_b64_tr_b16 v[154:155], v253 offset:3072
s_waitcnt lgkmcnt(0)
s_bfe_u32 s87, s94, 0x40010
s_lshl_b32 s93, s87, 15
s_add_u32 s93, s93, s91
s_add_u32 m0, s75, 98304
s_add_u32 s87, s93, 0
buffer_load_dwordx4 v3, s[32:35], s87 offen  lds
s_add_u32 m0, s75, 99328
s_add_u32 s87, s93, 8192
buffer_load_dwordx4 v3, s[32:35], s87 offen  lds
s_add_u32 m0, s75, 100352
s_add_u32 s87, s93, 16384
buffer_load_dwordx4 v3, s[32:35], s87 offen  lds
s_add_u32 m0, s75, 101376
s_add_u32 s87, s93, 24576
buffer_load_dwordx4 v3, s[32:35], s87 offen  lds
ds_read_b64_tr_b16 v[156:157], v252 offset:32768
ds_read_b64_tr_b16 v[158:159], v252 offset:33792
ds_read_b64_tr_b16 v[160:161], v253 offset:32768
ds_read_b64_tr_b16 v[162:163], v253 offset:33792
ds_read_b64_tr_b16 v[164:165], v252 offset:34816
ds_read_b64_tr_b16 v[166:167], v252 offset:35840
ds_read_b64_tr_b16 v[168:169], v253 offset:34816
ds_read_b64_tr_b16 v[170:171], v253 offset:35840
s_waitcnt lgkmcnt(0)
s_bfe_u32 s87, s94, 0x40014
s_lshl_b32 s93, s87, 15
s_add_u32 s93, s93, s91
s_add_u32 m0, s75, 131072
s_add_u32 s87, s93, 0
buffer_load_dwordx4 v3, s[32:35], s87 offen  lds
s_add_u32 m0, s75, 132096
s_add_u32 s87, s93, 8192
buffer_load_dwordx4 v3, s[32:35], s87 offen  lds
s_add_u32 m0, s75, 133120
s_add_u32 s87, s93, 16384
buffer_load_dwordx4 v3, s[32:35], s87 offen  lds
s_add_u32 m0, s75, 134144
s_add_u32 s87, s93, 24576
buffer_load_dwordx4 v3, s[32:35], s87 offen  lds
ds_read_b64_tr_b16 v[172:173], v4 offset:0
ds_read_b64_tr_b16 v[174:175], v4 offset:1024
ds_read_b64_tr_b16 v[176:177], v5 offset:0
ds_read_b64_tr_b16 v[178:179], v5 offset:1024
ds_read_b64_tr_b16 v[180:181], v4 offset:2048
ds_read_b64_tr_b16 v[182:183], v4 offset:3072
ds_read_b64_tr_b16 v[184:185], v5 offset:2048
ds_read_b64_tr_b16 v[186:187], v5 offset:3072
s_waitcnt lgkmcnt(0)
s_bfe_u32 s87, s94, 0x40018
s_lshl_b32 s93, s87, 15
s_add_u32 s93, s93, s91
s_add_u32 m0, s75, 0
s_add_u32 s87, s93, 0
buffer_load_dwordx4 v3, s[32:35], s87 offen  lds
s_add_u32 m0, s75, 1024
s_add_u32 s87, s93, 8192
buffer_load_dwordx4 v3, s[32:35], s87 offen  lds
s_add_u32 m0, s75, 2048
s_add_u32 s87, s93, 16384
buffer_load_dwordx4 v3, s[32:35], s87 offen  lds
s_add_u32 m0, s75, 3072
s_add_u32 s87, s93, 24576
buffer_load_dwordx4 v3, s[32:35], s87 offen  lds
ds_read_b64_tr_b16 v[188:189], v4 offset:32768
ds_read_b64_tr_b16 v[190:191], v4 offset:33792
ds_read_b64_tr_b16 v[192:193], v5 offset:32768
ds_read_b64_tr_b16 v[194:195], v5 offset:33792
ds_read_b64_tr_b16 v[196:197], v4 offset:34816
ds_read_b64_tr_b16 v[198:199], v4 offset:35840
ds_read_b64_tr_b16 v[200:201], v5 offset:34816
ds_read_b64_tr_b16 v[202:203], v5 offset:35840
s_waitcnt lgkmcnt(0)
s_bfe_u32 s87, s94, 0x4001c
s_lshl_b32 s93, s87, 15
s_add_u32 s93, s93, s91
s_add_u32 m0, s75, 32768
s_add_u32 s87, s93, 0
buffer_load_dwordx4 v3, s[32:35], s87 offen  lds
s_add_u32 m0, s75, 33792
s_add_u32 s87, s93, 8192
buffer_load_dwordx4 v3, s[32:35], s87 offen  lds
s_add_u32 m0, s75, 34816
s_add_u32 s87, s93, 16384
buffer_load_dwordx4 v3, s[32:35], s87 offen  lds
s_add_u32 m0, s75, 35840
s_add_u32 s87, s93, 24576
buffer_load_dwordx4 v3, s[32:35], s87 offen  lds
s_waitcnt vmcnt(12)
ds_read_b64_tr_b16 v[204:205], v252 offset:0
ds_read_b64_tr_b16 v[206:207], v252 offset:1024
ds_read_b64_tr_b16 v[208:209], v253 offset:0
ds_read_b64_tr_b16 v[210:211], v253 offset:1024
ds_read_b64_tr_b16 v[212:213], v252 offset:2048
ds_read_b64_tr_b16 v[214:215], v252 offset:3072
ds_read_b64_tr_b16 v[216:217], v253 offset:2048
ds_read_b64_tr_b16 v[218:219], v253 offset:3072
s_waitcnt lgkmcnt(0)
s_bfe_u32 s87, s95, 0x40000
s_lshl_b32 s93, s87, 15
s_add_u32 s93, s93, s91
s_add_u32 m0, s75, 98304
s_add_u32 s87, s93, 0
buffer_load_dwordx4 v3, s[32:35], s87 offen  lds
s_add_u32 m0, s75, 99328
s_add_u32 s87, s93, 8192
buffer_load_dwordx4 v3, s[32:35], s87 offen  lds
s_add_u32 m0, s75, 100352
s_add_u32 s87, s93, 16384
buffer_load_dwordx4 v3, s[32:35], s87 offen  lds
s_add_u32 m0, s75, 101376
s_add_u32 s87, s93, 24576
buffer_load_dwordx4 v3, s[32:35], s87 offen  lds
s_waitcnt vmcnt(12)
ds_read_b64_tr_b16 v[220:221], v252 offset:32768
ds_read_b64_tr_b16 v[222:223], v252 offset:33792
ds_read_b64_tr_b16 v[224:225], v253 offset:32768
ds_read_b64_tr_b16 v[226:227], v253 offset:33792
ds_read_b64_tr_b16 v[228:229], v252 offset:34816
ds_read_b64_tr_b16 v[230:231], v252 offset:35840
ds_read_b64_tr_b16 v[232:233], v253 offset:34816
ds_read_b64_tr_b16 v[234:235], v253 offset:35840
s_waitcnt lgkmcnt(0)
s_bfe_u32 s87, s95, 0x40004
s_lshl_b32 s93, s87, 15
s_add_u32 s93, s93, s91
s_add_u32 m0, s75, 131072
s_add_u32 s87, s93, 0
buffer_load_dwordx4 v3, s[32:35], s87 offen  lds
s_add_u32 m0, s75, 132096
s_add_u32 s87, s93, 8192
buffer_load_dwordx4 v3, s[32:35], s87 offen  lds
s_add_u32 m0, s75, 133120
s_add_u32 s87, s93, 16384
buffer_load_dwordx4 v3, s[32:35], s87 offen  lds
s_add_u32 m0, s75, 134144
s_add_u32 s87, s93, 24576
buffer_load_dwordx4 v3, s[32:35], s87 offen  lds
s_waitcnt vmcnt(12)
ds_read_b64_tr_b16 v[236:237], v4 offset:0
ds_read_b64_tr_b16 v[238:239], v4 offset:1024
ds_read_b64_tr_b16 v[240:241], v5 offset:0
ds_read_b64_tr_b16 v[242:243], v5 offset:1024
ds_read_b64_tr_b16 v[244:245], v4 offset:2048
ds_read_b64_tr_b16 v[246:247], v4 offset:3072
ds_read_b64_tr_b16 v[248:249], v5 offset:2048
ds_read_b64_tr_b16 v[250:251], v5 offset:3072
s_waitcnt lgkmcnt(0)
s_bfe_u32 s87, s95, 0x40008
s_lshl_b32 s93, s87, 15
s_add_u32 s93, s93, s91
s_add_u32 m0, s75, 0
s_add_u32 s87, s93, 0
buffer_load_dwordx4 v3, s[32:35], s87 offen  lds
s_add_u32 m0, s75, 1024
s_add_u32 s87, s93, 8192
buffer_load_dwordx4 v3, s[32:35], s87 offen  lds
s_add_u32 m0, s75, 2048
s_add_u32 s87, s93, 16384
buffer_load_dwordx4 v3, s[32:35], s87 offen  lds
s_add_u32 m0, s75, 3072
s_add_u32 s87, s93, 24576
buffer_load_dwordx4 v3, s[32:35], s87 offen  lds
s_cmp_lg_u32 s52, 0
s_cbranch_scc1 LF_wait
s_mov_b32 exec_hi, 0
s_branch LF_poll1
LF_poll:
LF_poll1:
buffer_load_dword v6, v10, s[48:51], s62 offen sc1
s_waitcnt vmcnt(0)
v_cmp_ne_u32 vcc, 1, v6
s_nop 3
s_cmp_eq_u64 vcc, 0
s_cselect_b32 s77, 1, 0
s_cbranch_scc1 LF_go
s_sub_u32 s74, s74, 1
s_cmp_lg_u32 s74, 0
s_cbranch_scc1 LF_poll
s_mov_b64 exec, 1
buffer_atomic_add v11, off, s[68:71], s72 sc0 sc1
v_mov_b32 v6, v9
buffer_atomic_add v6, off, s[68:71], s73 sc0 sc1
s_waitcnt vmcnt(0)
v_readfirstlane_b32 s78, v6
s_nop 2
s_and_b32 s78, s78, 0xffff
s_cmp_eq_u32 s78, 32
s_cselect_b32 s77, 1, 0
s_branch LF_go2
LF_go:
s_mov_b64 exec, 1
buffer_atomic_add v11, off, s[68:71], s72 sc0 sc1
LF_go2:
v_mov_b32 v8, s77
ds_write_b32 v9, v8
s_waitcnt lgkmcnt(0)
s_mov_b64 exec, -1
LF_wait:
s_barrier
ds_read_b32 v8, v9
s_mov_b32 s61, 0
s_waitcnt lgkmcnt(0)
v_readfirstlane_b32 s77, v8
s_nop 2
s_cmp_eq_u32 s77, 1
s_cbranch_scc1 LF_mid
s_waitcnt vmcnt(0)
LF_next:
s_cmp_lg_u32 s61, 0
s_cbranch_scc1 LF_more
v_mov_b32 v10, 0x10004
s_cmp_lg_u32 s52, 0
s_cbranch_scc1 LF_wait2
s_mov_b64 exec, 1
ds_write_b32 v10, v11
s_waitcnt lgkmcnt(0)
s_mov_b64 exec, -1
LF_wait2:
s_barrier
ds_read_b32 v8, v10
s_waitcnt lgkmcnt(0)
v_readfirstlane_b32 s77, v8
s_nop 2
s_cmp_lt_u32 s77, 0x10000
s_cbranch_scc1 LF_end
s_and_b32 s77, s77, 0xffff
s_cmp_lg_u32 s77, 31
s_cbranch_scc1 LF_end
LF_more:
s_cmp_eq_u32 s61, 32
s_cbranch_scc1 LF_end
s_waitcnt vmcnt(0)
s_lshr_b32 s98, s2, 6
s_lshl_b32 s98, s98, 1
s_add_u32 s98, s98, s57
s_lshl_b32 s78, s61, 3
s_add_u32 s98, s98, s78
s_add_u32 s61, s61, 1
s_barrier
s_lshl_b32 s75, s52, 12
s_and_b32 s84, s98, 1
s_lshr_b32 s87, s98, 1
s_and_b32 s87, s87, 3
s_lshl_b32 s87, s87, 2
s_lshr_b32 s88, s98, 3
s_and_b32 s88, s88, 3
s_add_u32 s85, s87, s88
s_lshr_b32 s86, s98, 5
v_lshlrev_b32 v2, 4, v1
v_lshrrev_b32 v8, 3, v1
v_and_b32 v9, 7, v1
v_bfe_u32 v17, v1, 4, 1
v_lshlrev_b32 v17, 2, v17
v_xor_b32 v9, v9, v17
v_lshlrev_b32 v9, 4, v9
v_lshl_add_u32 v3, v8, 10, v9
s_cmp_eq_u32 s84, 1
s_cselect_b32 s32, s22, s12
s_cselect_b32 s33, s23, s13
s_mov_b32 s34, 0x400000
s_mov_b32 s35, 0x00020000
s_mov_b32 s36, s28
s_mov_b32 s37, s29
s_mov_b32 s38, 0x1000000
s_mov_b32 s39, 0x00020000
s_mov_b32 s40, s24
s_mov_b32 s41, s25
s_mov_b32 s42, 0x200000
s_mov_b32 s43, 0x00020000
s_lshl_b32 s89, s84, 4
s_add_u32 s89, s89, s85
s_lshl_b32 s89, s89, 19
s_lshl_b32 s87, s52, 15
s_add_u32 s89, s89, s87
s_add_u32 s90, s89, 0x40000
s_lshl_b32 s91, s52, 19
s_lshl_b32 s87, s86, 7
s_add_u32 s91, s91, s87
s_lshr_b32 s87, s52, 2
s_lshl_b32 s87, s87, 1
s_add_u32 s87, s87, s52
s_lshl_b32 s92, s87, 14
s_add_u32 s87, s85, s86
s_and_b32 s87, s87, 3
s_mov_b32 s94, 0x65832140
s_mov_b32 s95, 0xfedba9c7
s_cmp_eq_u32 s87, 1
s_cmov_b32 s94, 0x69432501
s_cmov_b32 s95, 0xfecbad87
s_cmp_eq_u32 s87, 2
s_cmov_b32 s94, 0xa5436102
s_cmov_b32 s95, 0xfdcbe987
s_cmp_eq_u32 s87, 3
s_cmov_b32 s94, 0x65472103
s_cmov_b32 s95, 0xedcfa98b
v_bfe_u32 v8, v1, 2, 2
v_lshrrev_b32 v9, 5, v1
v_lshl_add_u32 v9, v9, 2, v8
v_lshlrev_b32 v4, 7, v9
v_lshrrev_b32 v8, 1, v8
v_lshl_add_u32 v4, v8, 6, v4
v_and_b32 v8, 1, v1
v_lshl_add_u32 v4, v8, 5, v4
v_bfe_u32 v8, v1, 4, 1
v_lshl_add_u32 v4, v8, 4, v4
v_bfe_u32 v8, v1, 1, 1
v_lshl_add_u32 v4, v8, 3, v4
v_add_u32 v4, s75, v4
v_xor_b32 v5, 64, v4
s_bfe_u32 s87, s94, 0x40000
s_lshl_b32 s93, s87, 15
s_add_u32 s93, s93, s91
s_add_u32 m0, s75, 98304
s_add_u32 s87, s93, 0
buffer_load_dwordx4 v3, s[32:35], s87 offen  lds
s_add_u32 m0, s75, 99328
s_add_u32 s87, s93, 8192
buffer_load_dwordx4 v3, s[32:35], s87 offen  lds
s_add_u32 m0, s75, 100352
s_add_u32 s87, s93, 16384
buffer_load_dwordx4 v3, s[32:35], s87 offen  lds
s_add_u32 m0, s75, 101376
s_add_u32 s87, s93, 24576
buffer_load_dwordx4 v3, s[32:35], s87 offen  lds
s_bfe_u32 s87, s94, 0x40004
s_lshl_b32 s93, s87, 15
s_add_u32 s93, s93, s91
s_add_u32 m0, s75, 131072
s_add_u32 s87, s93, 0
buffer_load_dwordx4 v3, s[32:35], s87 offen  lds
s_add_u32 m0, s75, 132096
s_add_u32 s87, s93, 8192
buffer_load_dwordx4 v3, s[32:35], s87 offen  lds
s_add_u32 m0, s75, 133120
s_add_u32 s87, s93, 16384
buffer_load_dwordx4 v3, s[32:35], s87 offen  lds
s_add_u32 m0, s75, 134144
s_add_u32 s87, s93, 24576
buffer_load_dwordx4 v3, s[32:35], s87 offen  lds
s_bfe_u32 s87, s94, 0x40008
s_lshl_b32 s93, s87, 15
s_add_u32 s93, s93, s91
s_add_u32 m0, s75, 0
s_add_u32 s87, s93, 0
buffer_load_dwordx4 v3, s[32:35], s87 offen  lds
s_add_u32 m0, s75, 1024
s_add_u32 s87, s93, 8192
buffer_load_dwordx4 v3, s[32:35], s87 offen  lds
s_add_u32 m0, s75, 2048
s_add_u32 s87, s93, 16384
buffer_load_dwordx4 v3, s[32:35], s87 offen  lds
s_add_u32 m0, s75, 3072
s_add_u32 s87, s93, 24576
buffer_load_dwordx4 v3, s[32:35], s87 offen  lds
s_bfe_u32 s87, s94, 0x4000c
s_lshl_b32 s93, s87, 15
s_add_u32 s93, s93, s91
s_add_u32 m0, s75, 32768
s_add_u32 s87, s93, 0
buffer_load_dwordx4 v3, s[32:35], s87 offen  lds
s_add_u32 m0, s75, 33792
s_add_u32 s87, s93, 8192
buffer_load_dwordx4 v3, s[32:35], s87 offen  lds
s_add_u32 m0, s75, 34816
s_add_u32 s87, s93, 16384
buffer_load_dwordx4 v3, s[32:35], s87 offen  lds
s_add_u32 m0, s75, 35840
s_add_u32 s87, s93, 24576
buffer_load_dwordx4 v3, s[32:35], s87 offen  lds
s_waitcnt vmcnt(0)
v_add_u32 v252, 98304, v4
v_add_u32 v253, 98304, v5
ds_read_b64_tr_b16 v[140:141], v252 offset:0
ds_read_b64_tr_b16 v[142:143], v252 offset:1024
ds_read_b64_tr_b16 v[144:145], v253 offset:0
ds_read_b64_tr_b16 v[146:147], v253 offset:1024
ds_read_b64_tr_b16 v[148:149], v252 offset:2048
ds_read_b64_tr_b16 v[150:151], v252 offset:3072
ds_read_b64_tr_b16 v[152:153], v253 offset:2048
ds_read_b64_tr_b16 v[154:155], v253 offset:3072
s_waitcnt lgkmcnt(0)
s_bfe_u32 s87, s94, 0x40010
s_lshl_b32 s93, s87, 15
s_add_u32 s93, s93, s91
s_add_u32 m0, s75, 98304
s_add_u32 s87, s93, 0
buffer_load_dwordx4 v3, s[32:35], s87 offen  lds
s_add_u32 m0, s75, 99328
s_add_u32 s87, s93, 8192
buffer_load_dwordx4 v3, s[32:35], s87 offen  lds
s_add_u32 m0, s75, 100352
s_add_u32 s87, s93, 16384
buffer_load_dwordx4 v3, s[32:35], s87 offen  lds
s_add_u32 m0, s75, 101376
s_add_u32 s87, s93, 24576
buffer_load_dwordx4 v3, s[32:35], s87 offen  lds
ds_read_b64_tr_b16 v[156:157], v252 offset:32768
ds_read_b64_tr_b16 v[158:159], v252 offset:33792
ds_read_b64_tr_b16 v[160:161], v253 offset:32768
ds_read_b64_tr_b16 v[162:163], v253 offset:33792
ds_read_b64_tr_b16 v[164:165], v252 offset:34816
ds_read_b64_tr_b16 v[166:167], v252 offset:35840
ds_read_b64_tr_b16 v[168:169], v253 offset:34816
ds_read_b64_tr_b16 v[170:171], v253 offset:35840
s_waitcnt lgkmcnt(0)
s_bfe_u32 s87, s94, 0x40014
s_lshl_b32 s93, s87, 15
s_add_u32 s93, s93, s91
s_add_u32 m0, s75, 131072
s_add_u32 s87, s93, 0
buffer_load_dwordx4 v3, s[32:35], s87 offen  lds
s_add_u32 m0, s75, 132096
s_add_u32 s87, s93, 8192
buffer_load_dwordx4 v3, s[32:35], s87 offen  lds
s_add_u32 m0, s75, 133120
s_add_u32 s87, s93, 16384
buffer_load_dwordx4 v3, s[32:35], s87 offen  lds
s_add_u32 m0, s75, 134144
s_add_u32 s87, s93, 24576
buffer_load_dwordx4 v3, s[32:35], s87 offen  lds
ds_read_b64_tr_b16 v[172:173], v4 offset:0
ds_read_b64_tr_b16 v[174:175], v4 offset:1024
ds_read_b64_tr_b16 v[176:177], v5 offset:0
ds_read_b64_tr_b16 v[178:179], v5 offset:1024
ds_read_b64_tr_b16 v[180:181], v4 offset:2048
ds_read_b64_tr_b16 v[182:183], v4 offset:3072
ds_read_b64_tr_b16 v[184:185], v5 offset:2048
ds_read_b64_tr_b16 v[186:187], v5 offset:3072
s_waitcnt lgkmcnt(0)
s_bfe_u32 s87, s94, 0x40018
s_lshl_b32 s93, s87, 15
s_add_u32 s93, s93, s91
s_add_u32 m0, s75, 0
s_add_u32 s87, s93, 0
buffer_load_dwordx4 v3, s[32:35], s87 offen  lds
s_add_u32 m0, s75, 1024
s_add_u32 s87, s93, 8192
buffer_load_dwordx4 v3, s[32:35], s87 offen  lds
s_add_u32 m0, s75, 2048
s_add_u32 s87, s93, 16384
buffer_load_dwordx4 v3, s[32:35], s87 offen  lds
s_add_u32 m0, s75, 3072
s_add_u32 s87, s93, 24576
buffer_load_dwordx4 v3, s[32:35], s87 offen  lds
ds_read_b64_tr_b16 v[188:189], v4 offset:32768
ds_read_b64_tr_b16 v[190:191], v4 offset:33792
ds_read_b64_tr_b16 v[192:193], v5 offset:32768
ds_read_b64_tr_b16 v[194:195], v5 offset:33792
ds_read_b64_tr_b16 v[196:197], v4 offset:34816
ds_read_b64_tr_b16 v[198:199], v4 offset:35840
ds_read_b64_tr_b16 v[200:201], v5 offset:34816
ds_read_b64_tr_b16 v[202:203], v5 offset:35840
s_waitcnt lgkmcnt(0)
s_bfe_u32 s87, s94, 0x4001c
s_lshl_b32 s93, s87, 15
s_add_u32 s93, s93, s91
s_add_u32 m0, s75, 32768
s_add_u32 s87, s93, 0
buffer_load_dwordx4 v3, s[32:35], s87 offen  lds
s_add_u32 m0, s75, 33792
s_add_u32 s87, s93, 8192
buffer_load_dwordx4 v3, s[32:35], s87 offen  lds
s_add_u32 m0, s75, 34816
s_add_u32 s87, s93, 16384
buffer_load_dwordx4 v3, s[32:35], s87 offen  lds
s_add_u32 m0, s75, 35840
s_add_u32 s87, s93, 24576
buffer_load_dwordx4 v3, s[32:35], s87 offen  lds
s_waitcnt vmcnt(12)
ds_read_b64_tr_b16 v[204:205], v252 offset:0
ds_read_b64_tr_b16 v[206:207], v252 offset:1024
ds_read_b64_tr_b16 v[208:209], v253 offset:0
ds_read_b64_tr_b16 v[210:211], v253 offset:1024
ds_read_b64_tr_b16 v[212:213], v252 offset:2048
ds_read_b64_tr_b16 v[214:215], v252 offset:3072
ds_read_b64_tr_b16 v[216:217], v253 offset:2048
ds_read_b64_tr_b16 v[218:219], v253 offset:3072
s_waitcnt lgkmcnt(0)
s_bfe_u32 s87, s95, 0x40000
s_lshl_b32 s93, s87, 15
s_add_u32 s93, s93, s91
s_add_u32 m0, s75, 98304
s_add_u32 s87, s93, 0
buffer_load_dwordx4 v3, s[32:35], s87 offen  lds
s_add_u32 m0, s75, 99328
s_add_u32 s87, s93, 8192
buffer_load_dwordx4 v3, s[32:35], s87 offen  lds
s_add_u32 m0, s75, 100352
s_add_u32 s87, s93, 16384
buffer_load_dwordx4 v3, s[32:35], s87 offen  lds
s_add_u32 m0, s75, 101376
s_add_u32 s87, s93, 24576
buffer_load_dwordx4 v3, s[32:35], s87 offen  lds
s_waitcnt vmcnt(12)
ds_read_b64_tr_b16 v[220:221], v252 offset:32768
ds_read_b64_tr_b16 v[222:223], v252 offset:33792
ds_read_b64_tr_b16 v[224:225], v253 offset:32768
ds_read_b64_tr_b16 v[226:227], v253 offset:33792
ds_read_b64_tr_b16 v[228:229], v252 offset:34816
ds_read_b64_tr_b16 v[230:231], v252 offset:35840
ds_read_b64_tr_b16 v[232:233], v253 offset:34816
ds_read_b64_tr_b16 v[234:235], v253 offset:35840
s_waitcnt lgkmcnt(0)
s_bfe_u32 s87, s95, 0x40004
s_lshl_b32 s93, s87, 15
s_add_u32 s93, s93, s91
s_add_u32 m0, s75, 131072
s_add_u32 s87, s93, 0
buffer_load_dwordx4 v3, s[32:35], s87 offen  lds
s_add_u32 m0, s75, 132096
s_add_u32 s87, s93, 8192
buffer_load_dwordx4 v3, s[32:35], s87 offen  lds
s_add_u32 m0, s75, 133120
s_add_u32 s87, s93, 16384
buffer_load_dwordx4 v3, s[32:35], s87 offen  lds
s_add_u32 m0, s75, 134144
s_add_u32 s87, s93, 24576
buffer_load_dwordx4 v3, s[32:35], s87 offen  lds
s_waitcnt vmcnt(12)
ds_read_b64_tr_b16 v[236:237], v4 offset:0
ds_read_b64_tr_b16 v[238:239], v4 offset:1024
ds_read_b64_tr_b16 v[240:241], v5 offset:0
ds_read_b64_tr_b16 v[242:243], v5 offset:1024
ds_read_b64_tr_b16 v[244:245], v4 offset:2048
ds_read_b64_tr_b16 v[246:247], v4 offset:3072
ds_read_b64_tr_b16 v[248:249], v5 offset:2048
ds_read_b64_tr_b16 v[250:251], v5 offset:3072
s_waitcnt lgkmcnt(0)
s_bfe_u32 s87, s95, 0x40008
s_lshl_b32 s93, s87, 15
s_add_u32 s93, s93, s91
s_add_u32 m0, s75, 0
s_add_u32 s87, s93, 0
buffer_load_dwordx4 v3, s[32:35], s87 offen  lds
s_add_u32 m0, s75, 1024
s_add_u32 s87, s93, 8192
buffer_load_dwordx4 v3, s[32:35], s87 offen  lds
s_add_u32 m0, s75, 2048
s_add_u32 s87, s93, 16384
buffer_load_dwordx4 v3, s[32:35], s87 offen  lds
s_add_u32 m0, s75, 3072
s_add_u32 s87, s93, 24576
buffer_load_dwordx4 v3, s[32:35], s87 offen  lds
LF_mid:

s_bfe_u32 s87, s94, 0x40000
s_lshl_b32 s87, s87, 11
s_add_u32 s100, s89, s87
s_add_u32 s101, s90, s87
buffer_load_dwordx4 v[92:95], v2, s[36:39], s100 offen offset:0
buffer_load_dwordx4 v[96:99], v2, s[36:39], s101 offen offset:0
buffer_load_dwordx4 v[100:103], v2, s[36:39], s100 offen offset:1024
buffer_load_dwordx4 v[104:107], v2, s[36:39], s101 offen offset:1024
s_barrier
s_bfe_u32 s87, s94, 0x40004
s_lshl_b32 s87, s87, 11
s_add_u32 s100, s89, s87
s_add_u32 s101, s90, s87
buffer_load_dwordx4 v[108:111], v2, s[36:39], s100 offen offset:0
buffer_load_dwordx4 v[112:115], v2, s[36:39], s101 offen offset:0
buffer_load_dwordx4 v[116:119], v2, s[36:39], s100 offen offset:1024
buffer_load_dwordx4 v[120:123], v2, s[36:39], s101 offen offset:1024
s_barrier
s_bfe_u32 s87, s94, 0x40008
s_lshl_b32 s87, s87, 11
s_add_u32 s100, s89, s87
s_add_u32 s101, s90, s87
buffer_load_dwordx4 v[124:127], v2, s[36:39], s100 offen offset:0
buffer_load_dwordx4 v[128:131], v2, s[36:39], s101 offen offset:0
buffer_load_dwordx4 v[132:135], v2, s[36:39], s100 offen offset:1024
buffer_load_dwordx4 v[136:139], v2, s[36:39], s101 offen offset:1024
s_waitcnt vmcnt(10)
s_waitcnt vmcnt(8)
v_mfma_f32_32x32x16_bf16 v[12:27], v[140:143], v[92:95], 0
v_mfma_f32_32x32x16_bf16 v[28:43], v[140:143], v[96:99], 0
v_mfma_f32_32x32x16_bf16 v[44:59], v[144:147], v[92:95], 0
v_mfma_f32_32x32x16_bf16 v[60:75], v[144:147], v[96:99], 0
s_barrier
s_bfe_u32 s87, s94, 0x4000c
s_lshl_b32 s87, s87, 11
s_add_u32 s100, s89, s87
s_add_u32 s101, s90, s87
buffer_load_dwordx4 v[92:95], v2, s[36:39], s100 offen offset:0
buffer_load_dwordx4 v[96:99], v2, s[36:39], s101 offen offset:0
s_waitcnt vmcnt(8)
v_mfma_f32_32x32x16_bf16 v[12:27], v[148:151], v[100:103], v[12:27]
v_mfma_f32_32x32x16_bf16 v[28:43], v[148:151], v[104:107], v[28:43]
v_mfma_f32_32x32x16_bf16 v[44:59], v[152:155], v[100:103], v[44:59]
v_mfma_f32_32x32x16_bf16 v[60:75], v[152:155], v[104:107], v[60:75]
buffer_load_dwordx4 v[100:103], v2, s[36:39], s100 offen offset:1024
buffer_load_dwordx4 v[104:107], v2, s[36:39], s101 offen offset:1024
s_waitcnt vmcnt(8)
v_mfma_f32_32x32x16_bf16 v[12:27], v[156:159], v[108:111], v[12:27]
v_mfma_f32_32x32x16_bf16 v[28:43], v[156:159], v[112:115], v[28:43]
v_mfma_f32_32x32x16_bf16 v[44:59], v[160:163], v[108:111], v[44:59]
v_mfma_f32_32x32x16_bf16 v[60:75], v[160:163], v[112:115], v[60:75]
s_barrier
s_bfe_u32 s87, s94, 0x40010
s_lshl_b32 s87, s87, 11
s_add_u32 s100, s89, s87
s_add_u32 s101, s90, s87
buffer_load_dwordx4 v[108:111], v2, s[36:39], s100 offen offset:0
buffer_load_dwordx4 v[112:115], v2, s[36:39], s101 offen offset:0
s_waitcnt vmcnt(8)
v_mfma_f32_32x32x16_bf16 v[12:27], v[164:167], v[116:119], v[12:27]
v_mfma_f32_32x32x16_bf16 v[28:43], v[164:167], v[120:123], v[28:43]
v_mfma_f32_32x32x16_bf16 v[44:59], v[168:171], v[116:119], v[44:59]
v_mfma_f32_32x32x16_bf16 v[60:75], v[168:171], v[120:123], v[60:75]
buffer_load_dwordx4 v[116:119], v2, s[36:39], s100 offen offset:1024
buffer_load_dwordx4 v[120:123], v2, s[36:39], s101 offen offset:1024
s_waitcnt vmcnt(8)
v_mfma_f32_32x32x16_bf16 v[12:27], v[172:175], v[124:127], v[12:27]
v_mfma_f32_32x32x16_bf16 v[28:43], v[172:175], v[128:131], v[28:43]
v_mfma_f32_32x32x16_bf16 v[44:59], v[176:179], v[124:127], v[44:59]
v_mfma_f32_32x32x16_bf16 v[60:75], v[176:179], v[128:131], v[60:75]
s_barrier
s_bfe_u32 s87, s94, 0x40014
s_lshl_b32 s87, s87, 11
s_add_u32 s100, s89, s87
s_add_u32 s101, s90, s87
buffer_load_dwordx4 v[124:127], v2, s[36:39], s100 offen offset:0
buffer_load_dwordx4 v[128:131], v2, s[36:39], s101 offen offset:0
s_waitcnt vmcnt(8)
v_mfma_f32_32x32x16_bf16 v[12:27], v[180:183], v[132:135], v[12:27]
v_mfma_f32_32x32x16_bf16 v[28:43], v[180:183], v[136:139], v[28:43]
v_mfma_f32_32x32x16_bf16 v[44:59], v[184:187], v[132:135], v[44:59]
v_mfma_f32_32x32x16_bf16 v[60:75], v[184:187], v[136:139], v[60:75]
buffer_load_dwordx4 v[132:135], v2, s[36:39], s100 offen offset:1024
buffer_load_dwordx4 v[136:139], v2, s[36:39], s101 offen offset:1024
s_waitcnt vmcnt(8)
v_mfma_f32_32x32x16_bf16 v[12:27], v[188:191], v[92:95], v[12:27]
v_mfma_f32_32x32x16_bf16 v[28:43], v[188:191], v[96:99], v[28:43]
v_mfma_f32_32x32x16_bf16 v[44:59], v[192:195], v[92:95], v[44:59]
v_mfma_f32_32x32x16_bf16 v[60:75], v[192:195], v[96:99], v[60:75]
s_barrier
s_bfe_u32 s87, s94, 0x40018
s_lshl_b32 s87, s87, 11
s_add_u32 s100, s89, s87
s_add_u32 s101, s90, s87
buffer_load_dwordx4 v[92:95], v2, s[36:39], s100 offen offset:0
buffer_load_dwordx4 v[96:99], v2, s[36:39], s101 offen offset:0
s_waitcnt vmcnt(8)
v_mfma_f32_32x32x16_bf16 v[12:27], v[196:199], v[100:103], v[12:27]
v_mfma_f32_32x32x16_bf16 v[28:43], v[196:199], v[104:107], v[28:43]
v_mfma_f32_32x32x16_bf16 v[44:59], v[200:203], v[100:103], v[44:59]
v_mfma_f32_32x32x16_bf16 v[60:75], v[200:203], v[104:107], v[60:75]
buffer_load_dwordx4 v[100:103], v2, s[36:39], s100 offen offset:1024
buffer_load_dwordx4 v[104:107], v2, s[36:39], s101 offen offset:1024
s_waitcnt vmcnt(8)
v_mfma_f32_32x32x16_bf16 v[12:27], v[204:207], v[108:111], v[12:27]
v_mfma_f32_32x32x16_bf16 v[28:43], v[204:207], v[112:115], v[28:43]
v_mfma_f32_32x32x16_bf16 v[44:59], v[208:211], v[108:111], v[44:59]
v_mfma_f32_32x32x16_bf16 v[60:75], v[208:211], v[112:115], v[60:75]
s_barrier
s_bfe_u32 s87, s94, 0x4001c
s_lshl_b32 s87, s87, 11
s_add_u32 s100, s89, s87
s_add_u32 s101, s90, s87
buffer_load_dwordx4 v[108:111], v2, s[36:39], s100 offen offset:0
buffer_load_dwordx4 v[112:115], v2, s[36:39], s101 offen offset:0
s_waitcnt vmcnt(8)
v_mfma_f32_32x32x16_bf16 v[12:27], v[212:215], v[116:119], v[12:27]
v_mfma_f32_32x32x16_bf16 v[28:43], v[212:215], v[120:123], v[28:43]
v_mfma_f32_32x32x16_bf16 v[44:59], v[216:219], v[116:119], v[44:59]
v_mfma_f32_32x32x16_bf16 v[60:75], v[216:219], v[120:123], v[60:75]
buffer_load_dwordx4 v[116:119], v2, s[36:39], s100 offen offset:1024
buffer_load_dwordx4 v[120:123], v2, s[36:39], s101 offen offset:1024
s_waitcnt vmcnt(8)
v_mfma_f32_32x32x16_bf16 v[12:27], v[220:223], v[124:127], v[12:27]
v_mfma_f32_32x32x16_bf16 v[28:43], v[220:223], v[128:131], v[28:43]
v_mfma_f32_32x32x16_bf16 v[44:59], v[224:227], v[124:127], v[44:59]
v_mfma_f32_32x32x16_bf16 v[60:75], v[224:227], v[128:131], v[60:75]
s_barrier
s_bfe_u32 s87, s95, 0x40000
s_lshl_b32 s87, s87, 11
s_add_u32 s100, s89, s87
s_add_u32 s101, s90, s87
buffer_load_dwordx4 v[124:127], v2, s[36:39], s100 offen offset:0
buffer_load_dwordx4 v[128:131], v2, s[36:39], s101 offen offset:0
s_waitcnt vmcnt(8)
v_mfma_f32_32x32x16_bf16 v[12:27], v[228:231], v[132:135], v[12:27]
v_mfma_f32_32x32x16_bf16 v[28:43], v[228:231], v[136:139], v[28:43]
v_mfma_f32_32x32x16_bf16 v[44:59], v[232:235], v[132:135], v[44:59]
v_mfma_f32_32x32x16_bf16 v[60:75], v[232:235], v[136:139], v[60:75]
buffer_load_dwordx4 v[132:135], v2, s[36:39], s100 offen offset:1024
buffer_load_dwordx4 v[136:139], v2, s[36:39], s101 offen offset:1024
s_waitcnt vmcnt(8)
v_mfma_f32_32x32x16_bf16 v[12:27], v[236:239], v[92:95], v[12:27]
v_mfma_f32_32x32x16_bf16 v[28:43], v[236:239], v[96:99], v[28:43]
v_mfma_f32_32x32x16_bf16 v[44:59], v[240:243], v[92:95], v[44:59]
v_mfma_f32_32x32x16_bf16 v[60:75], v[240:243], v[96:99], v[60:75]
s_barrier
s_bfe_u32 s87, s95, 0x40004
s_lshl_b32 s87, s87, 11
s_add_u32 s100, s89, s87
s_add_u32 s101, s90, s87
buffer_load_dwordx4 v[92:95], v2, s[36:39], s100 offen offset:0
buffer_load_dwordx4 v[96:99], v2, s[36:39], s101 offen offset:0
s_waitcnt vmcnt(8)
ds_read_b64_tr_b16 v[76:77], v4 offset:32768
ds_read_b64_tr_b16 v[78:79], v4 offset:33792
ds_read_b64_tr_b16 v[80:81], v5 offset:32768
ds_read_b64_tr_b16 v[82:83], v5 offset:33792
s_waitcnt lgkmcnt(4)
v_mfma_f32_32x32x16_bf16 v[12:27], v[244:247], v[100:103], v[12:27]
v_mfma_f32_32x32x16_bf16 v[28:43], v[244:247], v[104:107], v[28:43]
v_mfma_f32_32x32x16_bf16 v[44:59], v[248:251], v[100:103], v[44:59]
v_mfma_f32_32x32x16_bf16 v[60:75], v[248:251], v[104:107], v[60:75]
buffer_load_dwordx4 v[100:103], v2, s[36:39], s100 offen offset:1024
buffer_load_dwordx4 v[104:107], v2, s[36:39], s101 offen offset:1024
s_waitcnt vmcnt(8)
ds_read_b64_tr_b16 v[84:85], v4 offset:34816
ds_read_b64_tr_b16 v[86:87], v4 offset:35840
ds_read_b64_tr_b16 v[88:89], v5 offset:34816
ds_read_b64_tr_b16 v[90:91], v5 offset:35840
s_waitcnt lgkmcnt(4)
v_mfma_f32_32x32x16_bf16 v[12:27], v[76:79], v[108:111], v[12:27]
v_mfma_f32_32x32x16_bf16 v[28:43], v[76:79], v[112:115], v[28:43]
v_mfma_f32_32x32x16_bf16 v[44:59], v[80:83], v[108:111], v[44:59]
v_mfma_f32_32x32x16_bf16 v[60:75], v[80:83], v[112:115], v[60:75]
s_barrier
s_bfe_u32 s87, s95, 0x4000c
s_lshl_b32 s93, s87, 15
s_add_u32 s93, s93, s91
s_add_u32 m0, s75, 32768
s_add_u32 s87, s93, 0
buffer_load_dwordx4 v3, s[32:35], s87 offen  lds
s_add_u32 m0, s75, 33792
s_add_u32 s87, s93, 8192
buffer_load_dwordx4 v3, s[32:35], s87 offen  lds
s_bfe_u32 s87, s95, 0x40008
s_lshl_b32 s87, s87, 11
s_add_u32 s100, s89, s87
s_add_u32 s101, s90, s87
buffer_load_dwordx4 v[108:111], v2, s[36:39], s100 offen offset:0
buffer_load_dwordx4 v[112:115], v2, s[36:39], s101 offen offset:0
s_waitcnt vmcnt(10)
ds_read_b64_tr_b16 v[76:77], v252 offset:0
ds_read_b64_tr_b16 v[78:79], v252 offset:1024
ds_read_b64_tr_b16 v[80:81], v253 offset:0
ds_read_b64_tr_b16 v[82:83], v253 offset:1024
s_waitcnt lgkmcnt(4)
v_mfma_f32_32x32x16_bf16 v[12:27], v[84:87], v[116:119], v[12:27]
v_mfma_f32_32x32x16_bf16 v[28:43], v[84:87], v[120:123], v[28:43]
v_mfma_f32_32x32x16_bf16 v[44:59], v[88:91], v[116:119], v[44:59]
v_mfma_f32_32x32x16_bf16 v[60:75], v[88:91], v[120:123], v[60:75]
s_add_u32 m0, s75, 34816
s_add_u32 s87, s93, 16384
buffer_load_dwordx4 v3, s[32:35], s87 offen  lds
s_add_u32 m0, s75, 35840
s_add_u32 s87, s93, 24576
buffer_load_dwordx4 v3, s[32:35], s87 offen  lds
buffer_load_dwordx4 v[116:119], v2, s[36:39], s100 offen offset:1024
buffer_load_dwordx4 v[120:123], v2, s[36:39], s101 offen offset:1024
s_waitcnt vmcnt(12)
ds_read_b64_tr_b16 v[84:85], v252 offset:2048
ds_read_b64_tr_b16 v[86:87], v252 offset:3072
ds_read_b64_tr_b16 v[88:89], v253 offset:2048
ds_read_b64_tr_b16 v[90:91], v253 offset:3072
s_waitcnt lgkmcnt(4)
v_mfma_f32_32x32x16_bf16 v[12:27], v[76:79], v[124:127], v[12:27]
v_mfma_f32_32x32x16_bf16 v[28:43], v[76:79], v[128:131], v[28:43]
v_mfma_f32_32x32x16_bf16 v[44:59], v[80:83], v[124:127], v[44:59]
v_mfma_f32_32x32x16_bf16 v[60:75], v[80:83], v[128:131], v[60:75]
s_barrier
s_bfe_u32 s87, s95, 0x40010
s_lshl_b32 s93, s87, 15
s_add_u32 s93, s93, s91
s_add_u32 m0, s75, 98304
s_add_u32 s87, s93, 0
buffer_load_dwordx4 v3, s[32:35], s87 offen  lds
s_add_u32 m0, s75, 99328
s_add_u32 s87, s93, 8192
buffer_load_dwordx4 v3, s[32:35], s87 offen  lds
s_bfe_u32 s87, s95, 0x4000c
s_lshl_b32 s87, s87, 11
s_add_u32 s100, s89, s87
s_add_u32 s101, s90, s87
buffer_load_dwordx4 v[124:127], v2, s[36:39], s100 offen offset:0
buffer_load_dwordx4 v[128:131], v2, s[36:39], s101 offen offset:0
s_waitcnt vmcnt(14)
ds_read_b64_tr_b16 v[76:77], v252 offset:32768
ds_read_b64_tr_b16 v[78:79], v252 offset:33792
ds_read_b64_tr_b16 v[80:81], v253 offset:32768
ds_read_b64_tr_b16 v[82:83], v253 offset:33792
s_waitcnt lgkmcnt(4)
v_mfma_f32_32x32x16_bf16 v[12:27], v[84:87], v[132:135], v[12:27]
v_mfma_f32_32x32x16_bf16 v[28:43], v[84:87], v[136:139], v[28:43]
v_mfma_f32_32x32x16_bf16 v[44:59], v[88:91], v[132:135], v[44:59]
v_mfma_f32_32x32x16_bf16 v[60:75], v[88:91], v[136:139], v[60:75]
s_add_u32 m0, s75, 100352
s_add_u32 s87, s93, 16384
buffer_load_dwordx4 v3, s[32:35], s87 offen  lds
s_add_u32 m0, s75, 101376
s_add_u32 s87, s93, 24576
buffer_load_dwordx4 v3, s[32:35], s87 offen  lds
buffer_load_dwordx4 v[132:135], v2, s[36:39], s100 offen offset:1024
buffer_load_dwordx4 v[136:139], v2, s[36:39], s101 offen offset:1024
s_waitcnt vmcnt(16)
ds_read_b64_tr_b16 v[84:85], v252 offset:34816
ds_read_b64_tr_b16 v[86:87], v252 offset:35840
ds_read_b64_tr_b16 v[88:89], v253 offset:34816
ds_read_b64_tr_b16 v[90:91], v253 offset:35840
s_waitcnt lgkmcnt(4)
v_mfma_f32_32x32x16_bf16 v[12:27], v[76:79], v[92:95], v[12:27]
v_mfma_f32_32x32x16_bf16 v[28:43], v[76:79], v[96:99], v[28:43]
v_mfma_f32_32x32x16_bf16 v[44:59], v[80:83], v[92:95], v[44:59]
v_mfma_f32_32x32x16_bf16 v[60:75], v[80:83], v[96:99], v[60:75]
s_barrier
s_bfe_u32 s87, s95, 0x40014
s_lshl_b32 s93, s87, 15
s_add_u32 s93, s93, s91
s_add_u32 m0, s75, 131072
s_add_u32 s87, s93, 0
buffer_load_dwordx4 v3, s[32:35], s87 offen  lds
s_add_u32 m0, s75, 132096
s_add_u32 s87, s93, 8192
buffer_load_dwordx4 v3, s[32:35], s87 offen  lds
s_bfe_u32 s87, s95, 0x40010
s_lshl_b32 s87, s87, 11
s_add_u32 s100, s89, s87
s_add_u32 s101, s90, s87
buffer_load_dwordx4 v[92:95], v2, s[36:39], s100 offen offset:0
buffer_load_dwordx4 v[96:99], v2, s[36:39], s101 offen offset:0
s_waitcnt vmcnt(16)
ds_read_b64_tr_b16 v[76:77], v4 offset:0
ds_read_b64_tr_b16 v[78:79], v4 offset:1024
ds_read_b64_tr_b16 v[80:81], v5 offset:0
ds_read_b64_tr_b16 v[82:83], v5 offset:1024
s_waitcnt lgkmcnt(4)
v_mfma_f32_32x32x16_bf16 v[12:27], v[84:87], v[100:103], v[12:27]
v_mfma_f32_32x32x16_bf16 v[28:43], v[84:87], v[104:107], v[28:43]
v_mfma_f32_32x32x16_bf16 v[44:59], v[88:91], v[100:103], v[44:59]
v_mfma_f32_32x32x16_bf16 v[60:75], v[88:91], v[104:107], v[60:75]
s_add_u32 m0, s75, 133120
s_add_u32 s87, s93, 16384
buffer_load_dwordx4 v3, s[32:35], s87 offen  lds
s_add_u32 m0, s75, 134144
s_add_u32 s87, s93, 24576
buffer_load_dwordx4 v3, s[32:35], s87 offen  lds
buffer_load_dwordx4 v[100:103], v2, s[36:39], s100 offen offset:1024
buffer_load_dwordx4 v[104:107], v2, s[36:39], s101 offen offset:1024
s_waitcnt vmcnt(16)
ds_read_b64_tr_b16 v[84:85], v4 offset:2048
ds_read_b64_tr_b16 v[86:87], v4 offset:3072
ds_read_b64_tr_b16 v[88:89], v5 offset:2048
ds_read_b64_tr_b16 v[90:91], v5 offset:3072
s_waitcnt lgkmcnt(4)
v_mfma_f32_32x32x16_bf16 v[12:27], v[76:79], v[108:111], v[12:27]
v_mfma_f32_32x32x16_bf16 v[28:43], v[76:79], v[112:115], v[28:43]
v_mfma_f32_32x32x16_bf16 v[44:59], v[80:83], v[108:111], v[44:59]
v_mfma_f32_32x32x16_bf16 v[60:75], v[80:83], v[112:115], v[60:75]
s_barrier
s_bfe_u32 s87, s95, 0x40018
s_lshl_b32 s93, s87, 15
s_add_u32 s93, s93, s91
s_add_u32 m0, s75, 0
s_add_u32 s87, s93, 0
buffer_load_dwordx4 v3, s[32:35], s87 offen  lds
s_add_u32 m0, s75, 1024
s_add_u32 s87, s93, 8192
buffer_load_dwordx4 v3, s[32:35], s87 offen  lds
s_bfe_u32 s87, s95, 0x40014
s_lshl_b32 s87, s87, 11
s_add_u32 s100, s89, s87
s_add_u32 s101, s90, s87
buffer_load_dwordx4 v[108:111], v2, s[36:39], s100 offen offset:0
buffer_load_dwordx4 v[112:115], v2, s[36:39], s101 offen offset:0
s_waitcnt vmcnt(16)
ds_read_b64_tr_b16 v[76:77], v4 offset:32768
ds_read_b64_tr_b16 v[78:79], v4 offset:33792
ds_read_b64_tr_b16 v[80:81], v5 offset:32768
ds_read_b64_tr_b16 v[82:83], v5 offset:33792
s_waitcnt lgkmcnt(4)
v_mfma_f32_32x32x16_bf16 v[12:27], v[84:87], v[116:119], v[12:27]
v_mfma_f32_32x32x16_bf16 v[28:43], v[84:87], v[120:123], v[28:43]
v_mfma_f32_32x32x16_bf16 v[44:59], v[88:91], v[116:119], v[44:59]
v_mfma_f32_32x32x16_bf16 v[60:75], v[88:91], v[120:123], v[60:75]
s_add_u32 m0, s75, 2048
s_add_u32 s87, s93, 16384
buffer_load_dwordx4 v3, s[32:35], s87 offen  lds
s_add_u32 m0, s75, 3072
s_add_u32 s87, s93, 24576
buffer_load_dwordx4 v3, s[32:35], s87 offen  lds
buffer_load_dwordx4 v[116:119], v2, s[36:39], s100 offen offset:1024
buffer_load_dwordx4 v[120:123], v2, s[36:39], s101 offen offset:1024
s_waitcnt vmcnt(16)
ds_read_b64_tr_b16 v[84:85], v4 offset:34816
ds_read_b64_tr_b16 v[86:87], v4 offset:35840
ds_read_b64_tr_b16 v[88:89], v5 offset:34816
ds_read_b64_tr_b16 v[90:91], v5 offset:35840
s_waitcnt lgkmcnt(4)
v_mfma_f32_32x32x16_bf16 v[12:27], v[76:79], v[124:127], v[12:27]
v_mfma_f32_32x32x16_bf16 v[28:43], v[76:79], v[128:131], v[28:43]
v_mfma_f32_32x32x16_bf16 v[44:59], v[80:83], v[124:127], v[44:59]
v_mfma_f32_32x32x16_bf16 v[60:75], v[80:83], v[128:131], v[60:75]
s_barrier
s_bfe_u32 s87, s95, 0x4001c
s_lshl_b32 s93, s87, 15
s_add_u32 s93, s93, s91
s_add_u32 m0, s75, 32768
s_add_u32 s87, s93, 0
buffer_load_dwordx4 v3, s[32:35], s87 offen  lds
s_add_u32 m0, s75, 33792
s_add_u32 s87, s93, 8192
buffer_load_dwordx4 v3, s[32:35], s87 offen  lds
s_bfe_u32 s87, s95, 0x40018
s_lshl_b32 s87, s87, 11
s_add_u32 s100, s89, s87
s_add_u32 s101, s90, s87
buffer_load_dwordx4 v[124:127], v2, s[36:39], s100 offen offset:0
buffer_load_dwordx4 v[128:131], v2, s[36:39], s101 offen offset:0
s_waitcnt vmcnt(16)
ds_read_b64_tr_b16 v[76:77], v252 offset:0
ds_read_b64_tr_b16 v[78:79], v252 offset:1024
ds_read_b64_tr_b16 v[80:81], v253 offset:0
ds_read_b64_tr_b16 v[82:83], v253 offset:1024
s_waitcnt lgkmcnt(4)
v_mfma_f32_32x32x16_bf16 v[12:27], v[84:87], v[132:135], v[12:27]
v_mfma_f32_32x32x16_bf16 v[28:43], v[84:87], v[136:139], v[28:43]
v_mfma_f32_32x32x16_bf16 v[44:59], v[88:91], v[132:135], v[44:59]
v_mfma_f32_32x32x16_bf16 v[60:75], v[88:91], v[136:139], v[60:75]
s_add_u32 m0, s75, 34816
s_add_u32 s87, s93, 16384
buffer_load_dwordx4 v3, s[32:35], s87 offen  lds
s_add_u32 m0, s75, 35840
s_add_u32 s87, s93, 24576
buffer_load_dwordx4 v3, s[32:35], s87 offen  lds
buffer_load_dwordx4 v[132:135], v2, s[36:39], s100 offen offset:1024
buffer_load_dwordx4 v[136:139], v2, s[36:39], s101 offen offset:1024
s_waitcnt vmcnt(16)
ds_read_b64_tr_b16 v[84:85], v252 offset:2048
ds_read_b64_tr_b16 v[86:87], v252 offset:3072
ds_read_b64_tr_b16 v[88:89], v253 offset:2048
ds_read_b64_tr_b16 v[90:91], v253 offset:3072
s_waitcnt lgkmcnt(4)
v_mfma_f32_32x32x16_bf16 v[12:27], v[76:79], v[92:95], v[12:27]
v_mfma_f32_32x32x16_bf16 v[28:43], v[76:79], v[96:99], v[28:43]
v_mfma_f32_32x32x16_bf16 v[44:59], v[80:83], v[92:95], v[44:59]
v_mfma_f32_32x32x16_bf16 v[60:75], v[80:83], v[96:99], v[60:75]
s_barrier
s_bfe_u32 s87, s95, 0x4001c
s_lshl_b32 s87, s87, 11
s_add_u32 s100, s89, s87
s_add_u32 s101, s90, s87
buffer_load_dwordx4 v[92:95], v2, s[36:39], s100 offen offset:0
buffer_load_dwordx4 v[96:99], v2, s[36:39], s101 offen offset:0
s_waitcnt vmcnt(14)
ds_read_b64_tr_b16 v[76:77], v252 offset:32768
ds_read_b64_tr_b16 v[78:79], v252 offset:33792
ds_read_b64_tr_b16 v[80:81], v253 offset:32768
ds_read_b64_tr_b16 v[82:83], v253 offset:33792
s_waitcnt lgkmcnt(4)
v_mfma_f32_32x32x16_bf16 v[12:27], v[84:87], v[100:103], v[12:27]
v_mfma_f32_32x32x16_bf16 v[28:43], v[84:87], v[104:107], v[28:43]
v_mfma_f32_32x32x16_bf16 v[44:59], v[88:91], v[100:103], v[44:59]
v_mfma_f32_32x32x16_bf16 v[60:75], v[88:91], v[104:107], v[60:75]
buffer_load_dwordx4 v[100:103], v2, s[36:39], s100 offen offset:1024
buffer_load_dwordx4 v[104:107], v2, s[36:39], s101 offen offset:1024
s_waitcnt vmcnt(12)
ds_read_b64_tr_b16 v[84:85], v252 offset:34816
ds_read_b64_tr_b16 v[86:87], v252 offset:35840
ds_read_b64_tr_b16 v[88:89], v253 offset:34816
ds_read_b64_tr_b16 v[90:91], v253 offset:35840
s_waitcnt lgkmcnt(4)
v_mfma_f32_32x32x16_bf16 v[12:27], v[76:79], v[108:111], v[12:27]
v_mfma_f32_32x32x16_bf16 v[28:43], v[76:79], v[112:115], v[28:43]
v_mfma_f32_32x32x16_bf16 v[44:59], v[80:83], v[108:111], v[44:59]
v_mfma_f32_32x32x16_bf16 v[60:75], v[80:83], v[112:115], v[60:75]
s_waitcnt vmcnt(8)
ds_read_b64_tr_b16 v[76:77], v4 offset:0
ds_read_b64_tr_b16 v[78:79], v4 offset:1024
ds_read_b64_tr_b16 v[80:81], v5 offset:0
ds_read_b64_tr_b16 v[82:83], v5 offset:1024
s_waitcnt lgkmcnt(4)
v_mfma_f32_32x32x16_bf16 v[12:27], v[84:87], v[116:119], v[12:27]
v_mfma_f32_32x32x16_bf16 v[28:43], v[84:87], v[120:123], v[28:43]
v_mfma_f32_32x32x16_bf16 v[44:59], v[88:91], v[116:119], v[44:59]
v_mfma_f32_32x32x16_bf16 v[60:75], v[88:91], v[120:123], v[60:75]
s_waitcnt vmcnt(4)
ds_read_b64_tr_b16 v[84:85], v4 offset:2048
ds_read_b64_tr_b16 v[86:87], v4 offset:3072
ds_read_b64_tr_b16 v[88:89], v5 offset:2048
ds_read_b64_tr_b16 v[90:91], v5 offset:3072
s_waitcnt lgkmcnt(4)
v_mfma_f32_32x32x16_bf16 v[12:27], v[76:79], v[124:127], v[12:27]
v_mfma_f32_32x32x16_bf16 v[28:43], v[76:79], v[128:131], v[28:43]
v_mfma_f32_32x32x16_bf16 v[44:59], v[80:83], v[124:127], v[44:59]
v_mfma_f32_32x32x16_bf16 v[60:75], v[80:83], v[128:131], v[60:75]
s_waitcnt vmcnt(2)
ds_read_b64_tr_b16 v[76:77], v4 offset:32768
ds_read_b64_tr_b16 v[78:79], v4 offset:33792
ds_read_b64_tr_b16 v[80:81], v5 offset:32768
ds_read_b64_tr_b16 v[82:83], v5 offset:33792
s_waitcnt lgkmcnt(4)
v_mfma_f32_32x32x16_bf16 v[12:27], v[84:87], v[132:135], v[12:27]
v_mfma_f32_32x32x16_bf16 v[28:43], v[84:87], v[136:139], v[28:43]
v_mfma_f32_32x32x16_bf16 v[44:59], v[88:91], v[132:135], v[44:59]
v_mfma_f32_32x32x16_bf16 v[60:75], v[88:91], v[136:139], v[60:75]
s_waitcnt vmcnt(0)
ds_read_b64_tr_b16 v[84:85], v4 offset:34816
ds_read_b64_tr_b16 v[86:87], v4 offset:35840
ds_read_b64_tr_b16 v[88:89], v5 offset:34816
ds_read_b64_tr_b16 v[90:91], v5 offset:35840
s_waitcnt lgkmcnt(4)
v_mfma_f32_32x32x16_bf16 v[12:27], v[76:79], v[92:95], v[12:27]
v_mfma_f32_32x32x16_bf16 v[28:43], v[76:79], v[96:99], v[28:43]
v_mfma_f32_32x32x16_bf16 v[44:59], v[80:83], v[92:95], v[44:59]
v_mfma_f32_32x32x16_bf16 v[60:75], v[80:83], v[96:99], v[60:75]
s_waitcnt lgkmcnt(0)
v_mfma_f32_32x32x16_bf16 v[12:27], v[84:87], v[100:103], v[12:27]
v_mfma_f32_32x32x16_bf16 v[28:43], v[84:87], v[104:107], v[28:43]
v_mfma_f32_32x32x16_bf16 v[44:59], v[88:91], v[100:103], v[44:59]
v_mfma_f32_32x32x16_bf16 v[60:75], v[88:91], v[104:107], v[60:75]
v_add_u32 v6, s92, v2
s_lshl_b32 s87, s52, 11
v_add_u32 v7, s87, v2
v_add_u32 v8, 0x18000, v7
s_barrier
s_nop 7
ds_write_b128 v6, v[12:15] offset:0
ds_write_b128 v6, v[16:19] offset:1024
ds_write_b128 v6, v[20:23] offset:2048
ds_write_b128 v6, v[24:27] offset:3072
ds_write_b128 v6, v[28:31] offset:4096
ds_write_b128 v6, v[32:35] offset:5120
ds_write_b128 v6, v[36:39] offset:6144
ds_write_b128 v6, v[40:43] offset:7168
ds_write_b128 v6, v[44:47] offset:8192
ds_write_b128 v6, v[48:51] offset:9216
ds_write_b128 v6, v[52:55] offset:10240
ds_write_b128 v6, v[56:59] offset:11264
ds_write_b128 v6, v[60:63] offset:12288
ds_write_b128 v6, v[64:67] offset:13312
ds_write_b128 v6, v[68:71] offset:14336
ds_write_b128 v6, v[72:75] offset:15360
s_waitcnt lgkmcnt(0)
s_barrier
ds_read_b128 v[12:15], v7 offset:0
ds_read_b128 v[16:19], v7 offset:1024
ds_read_b128 v[20:23], v7 offset:16384
ds_read_b128 v[24:27], v7 offset:17408
ds_read_b128 v[28:31], v7 offset:32768
ds_read_b128 v[32:35], v7 offset:33792
ds_read_b128 v[36:39], v7 offset:49152
ds_read_b128 v[40:43], v7 offset:50176
ds_read_b128 v[44:47], v8 offset:0
ds_read_b128 v[48:51], v8 offset:1024
ds_read_b128 v[52:55], v8 offset:16384
ds_read_b128 v[56:59], v8 offset:17408
ds_read_b128 v[60:63], v8 offset:32768
ds_read_b128 v[64:67], v8 offset:33792
ds_read_b128 v[68:71], v8 offset:49152
ds_read_b128 v[72:75], v8 offset:50176
v_and_b32 v6, 31, v1
v_lshlrev_b32 v6, 11, v6
v_lshrrev_b32 v9, 5, v1
v_lshl_add_u32 v6, v9, 5, v6
s_lshl_b32 s87, s85, 1
s_bfe_u32 s88, s52, 0x10001
s_add_u32 s87, s87, s88
s_lshl_b32 s87, s87, 16
s_lshl_b32 s88, s84, 10
s_add_u32 s87, s87, s88
s_lshl_b32 s88, s86, 7
s_add_u32 s87, s87, s88
s_lshr_b32 s88, s52, 2
s_lshl_b32 s88, s88, 6
s_add_u32 s87, s87, s88
s_and_b32 s88, s52, 1
s_lshl_b32 s88, s88, 4
s_add_u32 s87, s87, s88
s_waitcnt lgkmcnt(12)
v_add_f32 v12, v12, v20
v_add_f32 v13, v13, v21
v_add_f32 v14, v14, v22
v_add_f32 v15, v15, v23
v_add_f32 v16, v16, v24
v_add_f32 v17, v17, v25
v_add_f32 v18, v18, v26
v_add_f32 v19, v19, v27
s_waitcnt lgkmcnt(10)
v_add_f32 v12, v12, v28
v_add_f32 v13, v13, v29
v_add_f32 v14, v14, v30
v_add_f32 v15, v15, v31
v_add_f32 v16, v16, v32
v_add_f32 v17, v17, v33
v_add_f32 v18, v18, v34
v_add_f32 v19, v19, v35
s_waitcnt lgkmcnt(8)
v_add_f32 v12, v12, v36
v_add_f32 v13, v13, v37
v_add_f32 v14, v14, v38
v_add_f32 v15, v15, v39
v_add_f32 v16, v16, v40
v_add_f32 v17, v17, v41
v_add_f32 v18, v18, v42
v_add_f32 v19, v19, v43
s_waitcnt lgkmcnt(6)
v_add_f32 v12, v12, v44
v_add_f32 v13, v13, v45
v_add_f32 v14, v14, v46
v_add_f32 v15, v15, v47
v_add_f32 v16, v16, v48
v_add_f32 v17, v17, v49
v_add_f32 v18, v18, v50
v_add_f32 v19, v19, v51
s_waitcnt lgkmcnt(4)
v_add_f32 v12, v12, v52
v_add_f32 v13, v13, v53
v_add_f32 v14, v14, v54
v_add_f32 v15, v15, v55
v_add_f32 v16, v16, v56
v_add_f32 v17, v17, v57
v_add_f32 v18, v18, v58
v_add_f32 v19, v19, v59
s_waitcnt lgkmcnt(2)
v_add_f32 v12, v12, v60
v_add_f32 v13, v13, v61
v_add_f32 v14, v14, v62
v_add_f32 v15, v15, v63
v_add_f32 v16, v16, v64
v_add_f32 v17, v17, v65
v_add_f32 v18, v18, v66
v_add_f32 v19, v19, v67
s_waitcnt lgkmcnt(0)
v_add_f32 v12, v12, v68
v_add_f32 v13, v13, v69
v_add_f32 v14, v14, v70
v_add_f32 v15, v15, v71
v_add_f32 v16, v16, v72
v_add_f32 v17, v17, v73
v_add_f32 v18, v18, v74
v_add_f32 v19, v19, v75
v_cvt_pk_bf16_f32 v76, v12, v13
v_cvt_pk_bf16_f32 v77, v14, v15
v_cvt_pk_bf16_f32 v78, v16, v17
v_cvt_pk_bf16_f32 v79, v18, v19
buffer_store_dwordx4 v[76:79], v6, s[40:43], s87 offen
s_branch LF_next
LF_end:
s_waitcnt vmcnt(0)
L1_end:
s_endpgm
.section .rodata,"a"
.p2align 6
.amdhsa_kernel concat_heads__mha_block_cached__gqa_block_cached__near_ridge_kernel
  .amdhsa_next_free_vgpr 256
  .amdhsa_next_free_sgpr 102
  .amdhsa_accum_offset 256
  .amdhsa_group_segment_fixed_size 0
  .amdhsa_kernarg_size 104
  .amdhsa_user_sgpr_count 2
  .amdhsa_user_sgpr_kernarg_segment_ptr 1
  .amdhsa_system_sgpr_workgroup_id_x 1
.end_amdhsa_kernel
```
